```python
import torch

def _softmax(x, axis=-1):
    return torch.softmax(x, dim=axis)
def _gelu(x):
    return torch.nn.functional.gelu(x, approximate="tanh")
def _silu(x):
    return torch.nn.functional.silu(x)
def _sigmoid(x):
    return torch.sigmoid(x)
def _layernorm(x, axis=-1, eps=1e-5):
    m = x.mean(dim=axis, keepdim=True)
    v = x.var(dim=axis, keepdim=True, unbiased=False)
    return (x - m) / torch.sqrt(v + eps)
def _scatter_add(tgt, idx, src, axis=0):
    return tgt.clone().index_add_(axis, idx, src)
def _segment_sum(src, seg, n):
    out = torch.zeros((n,) + src.shape[1:], dtype=src.dtype)
    return out.index_add_(0, seg, src)
def _pad(x, pw):
    flat = tuple(v for pair in reversed(pw) for v in pair)
    return torch.nn.functional.pad(x, flat)

kernel_name = 'gather_scatter__edge_featured_mpnn_gatedgcn__graph'

def setup_inputs():

    _w = (lambda a: (lambda t: t.to(torch.bfloat16) if t.is_floating_point() else t)(torch.as_tensor(a)))
    N, deg, D, De = 25000, 32, 64, max(0, 1)
    E = N * deg
    return {
        "x": _w((lambda *s: torch.randn(*s, dtype=torch.bfloat16) * 0.8)(N, D)),
        "e_attr": _w((lambda *s: torch.randn(*s, dtype=torch.bfloat16) * 0.8)(E, De)),
        "src": _w((lambda lo, hi, *s: torch.randint(lo, hi, s))(0, N, E).to(torch.int64)),
        "dst": _w((lambda lo, hi, *s: torch.randint(lo, hi, s))(0, N, E).to(torch.int64)),
        "w_a": _w((lambda *s: torch.randn(*s, dtype=torch.bfloat16) * 0.8)(D, D)),
        "w_b": _w((lambda *s: torch.randn(*s, dtype=torch.bfloat16) * 0.8)(D, D)),
        "w_c": _w((lambda *s: torch.randn(*s, dtype=torch.bfloat16) * 0.8)(De, D)),
        "w_u": _w((lambda *s: torch.randn(*s, dtype=torch.bfloat16) * 0.05)(D, D)),
        "w_v": _w((lambda *s: torch.randn(*s, dtype=torch.bfloat16) * 0.05)(D, D)),
    }

def reference(x, e_attr, src, dst, w_a, w_b, w_c, w_u, w_v):
    N, D = x.shape
    hv = x @ w_v
    g = x[dst] @ w_a + x[src] @ w_b + e_attr @ w_c
    eta = _sigmoid(g)
    denom = _segment_sum(eta, dst, N) + 1e-6
    eta_n = eta / denom[dst]
    agg = _segment_sum(eta_n * hv[src], dst, N)
    z = x @ w_u + agg
    relu_z = torch.where(z > 0, z, 0 * z)
    return x + relu_z
```

```asm
; @launch kernel=k1_kernel grid=(258,1,1) block=(448,1,1) lds=27648
; @launch kernel=k2_kernel grid=(256,1,1) block=(512,1,1) lds=155776
.amdgcn_target "amdgcn-amd-amdhsa--gfx950"
.text
.globl k1_kernel
.p2align 8
.type k1_kernel,@function
k1_kernel:
    s_cmp_ge_u32 s2, 258
    s_cbranch_scc1 K1_END
    s_load_dwordx4 s[4:7], s[0:1], 16
    s_load_dwordx4 s[12:15], s[0:1], 0
    s_load_dwordx2 s[10:11], s[0:1], 88
    s_cmp_ge_u32 s2, 250
    s_cbranch_scc1 K1_PREP
    s_mul_i32 s16, s2, 12800
    v_lshlrev_b32 v1, 4, v0
    v_add_u32 v2, s16, v1
    v_add_u32 v3, 6400, v2
    s_lshr_b32 s17, s16, 1
    v_add_u32 v4, s17, v1
    v_lshlrev_b32 v5, 2, v0
    v_mov_b32 v6, 0
    v_lshrrev_b32 v28, 6, v0
    v_mov_b32 v29, 1
    v_readfirstlane_b32 s23, v28
    v_cmp_gt_u32 vcc, 256, v0
    s_and_saveexec_b64 s[18:19], vcc
    ds_write_b32 v5, v6 offset:0
    s_mov_b64 exec, s[18:19]
    v_cmp_gt_u32 vcc, 400, v0
    s_and_b64 exec, exec, vcc
    s_mov_b64 s[20:21], exec
    s_mov_b32 s22, 4294967198
    s_waitcnt lgkmcnt(0)
    global_load_dwordx4 v[8:11], v2, s[6:7]
    global_load_dwordx4 v[12:15], v3, s[6:7]
    s_barrier
    global_load_dwordx4 v[80:83], v2, s[4:5]
    global_load_dwordx4 v[84:87], v3, s[4:5]
    v_lshrrev_b32 v4, 1, v2
    v_lshrrev_b32 v7, 1, v3
    global_load_dwordx2 v[88:89], v4, s[14:15]
    global_load_dwordx2 v[90:91], v7, s[14:15]
    s_waitcnt vmcnt(5)
    v_mul_u32_u24 v32, 42800, v8
    v_lshrrev_b32 v32, 22, v32
    v_mad_i32_i24 v40, v32, s22, v8
    v_lshlrev_b32 v32, 2, v32
    v_mul_u32_u24 v33, 42800, v9
    v_lshrrev_b32 v33, 22, v33
    v_mad_i32_i24 v41, v33, s22, v9
    v_lshlrev_b32 v33, 2, v33
    v_mul_u32_u24 v34, 42800, v10
    v_lshrrev_b32 v34, 22, v34
    v_mad_i32_i24 v42, v34, s22, v10
    v_lshlrev_b32 v34, 2, v34
    v_mul_u32_u24 v35, 42800, v11
    v_lshrrev_b32 v35, 22, v35
    v_mad_i32_i24 v43, v35, s22, v11
    v_lshlrev_b32 v35, 2, v35
    ds_add_rtn_u32 v48, v32, v29 offset:0
    ds_add_rtn_u32 v49, v33, v29 offset:0
    ds_add_rtn_u32 v50, v34, v29 offset:0
    ds_add_rtn_u32 v51, v35, v29 offset:0
    s_waitcnt vmcnt(4)
    v_mul_u32_u24 v36, 42800, v12
    v_lshrrev_b32 v36, 22, v36
    v_mad_i32_i24 v44, v36, s22, v12
    v_lshlrev_b32 v36, 2, v36
    v_mul_u32_u24 v37, 42800, v13
    v_lshrrev_b32 v37, 22, v37
    v_mad_i32_i24 v45, v37, s22, v13
    v_lshlrev_b32 v37, 2, v37
    v_mul_u32_u24 v38, 42800, v14
    v_lshrrev_b32 v38, 22, v38
    v_mad_i32_i24 v46, v38, s22, v14
    v_lshlrev_b32 v38, 2, v38
    v_mul_u32_u24 v39, 42800, v15
    v_lshrrev_b32 v39, 22, v39
    v_mad_i32_i24 v47, v39, s22, v15
    v_lshlrev_b32 v39, 2, v39
    ds_add_rtn_u32 v52, v36, v29 offset:0
    ds_add_rtn_u32 v53, v37, v29 offset:0
    ds_add_rtn_u32 v54, v38, v29 offset:0
    ds_add_rtn_u32 v55, v39, v29 offset:0
    s_waitcnt lgkmcnt(0)
    s_barrier
    s_mov_b64 exec, -1
    v_and_b32 v30, 63, v0
    v_lshlrev_b32 v31, 4, v30
    ds_read_b128 v[8:11], v31 offset:0
    s_waitcnt lgkmcnt(0)
    v_add_u32 v12, v8, v9
    v_add_u32 v13, v12, v10
    v_add_u32 v14, v13, v11
    v_mov_b32 v15, v14
    s_nop 1
    v_add_u32_dpp v15, v15, v15 row_shr:1 row_mask:0xf bank_mask:0xf
    s_nop 1
    v_add_u32_dpp v15, v15, v15 row_shr:2 row_mask:0xf bank_mask:0xf
    s_nop 1
    v_add_u32_dpp v15, v15, v15 row_shr:4 row_mask:0xf bank_mask:0xf
    s_nop 1
    v_add_u32_dpp v15, v15, v15 row_shr:8 row_mask:0xf bank_mask:0xf
    s_nop 1
    v_add_u32_dpp v15, v15, v15 row_bcast:15 row_mask:0xa bank_mask:0xf
    s_nop 1
    v_add_u32_dpp v15, v15, v15 row_bcast:31 row_mask:0xc bank_mask:0xf
    v_sub_u32 v16, v15, v14
    v_add_u32 v17, v16, v8
    v_add_u32 v18, v16, v12
    v_add_u32 v19, v16, v13
    ds_write_b128 v31, v[16:19] offset:1024
    v_lshl_or_b32 v20, v17, 16, v16
    v_lshl_or_b32 v21, v18, 16, v17
    v_lshl_or_b32 v22, v19, 16, v18
    v_lshl_or_b32 v23, v15, 16, v19

    s_lshl_b32 s24, s2, 10
    s_add_u32 s24, s24, 7340032
    v_add_u32 v24, s24, v31

    s_waitcnt lgkmcnt(0)
    s_mov_b64 exec, s[20:21]
    ds_read_b32 v8, v32 offset:1024
    ds_read_b32 v9, v33 offset:1024
    ds_read_b32 v10, v34 offset:1024
    ds_read_b32 v11, v35 offset:1024
    ds_read_b32 v12, v36 offset:1024
    ds_read_b32 v13, v37 offset:1024
    ds_read_b32 v14, v38 offset:1024
    ds_read_b32 v15, v39 offset:1024
    s_waitcnt vmcnt(0)
    s_cmp_lg_u32 s23, 0
    s_cbranch_scc1 K1_NOTAB2
    s_mov_b64 exec, -1
    global_store_dwordx4 v24, v[20:23], s[10:11] sc0 sc1
    s_mov_b64 exec, s[20:21]
K1_NOTAB2:
    s_mul_i32 s17, s2, 100
    v_add_u32 v6, s17, v0
    v_lshlrev_b32 v6, 7, v6
    v_cmp_gt_u32 vcc, 100, v0
    s_and_b64 exec, exec, vcc
    global_load_dword v62, v6, s[12:13]
    s_mov_b64 exec, s[20:21]
    s_cmp_ge_u32 s2, 16
    s_cbranch_scc1 K1_NOCPF
    s_getpc_b64 s[26:27]
K1_CPF:
    s_add_u32 s26, s26, k2_kernel-K1_CPF
    s_addc_u32 s27, s27, 0
    v_lshlrev_b32 v60, 7, v0
    v_cmp_gt_u32 vcc, (K2_CODE_END-k2_kernel+127)/128, v0
    s_and_b64 exec, exec, vcc
    s_cbranch_execz K1_CPF_SKIP
    global_load_dword v63, v60, s[26:27]
K1_CPF_SKIP:
    s_mov_b64 exec, s[20:21]
K1_NOCPF:
    v_lshlrev_b32 v64, 7, v80
    v_lshl_or_b32 v64, v40, 24, v64
    v_lshlrev_b32 v66, 7, v81
    v_lshl_or_b32 v66, v41, 24, v66
    v_lshlrev_b32 v68, 7, v82
    v_lshl_or_b32 v68, v42, 24, v68
    v_lshlrev_b32 v70, 7, v83
    v_lshl_or_b32 v70, v43, 24, v70
    v_lshlrev_b32 v72, 7, v84
    v_lshl_or_b32 v72, v44, 24, v72
    v_lshlrev_b32 v74, 7, v85
    v_lshl_or_b32 v74, v45, 24, v74
    v_lshlrev_b32 v76, 7, v86
    v_lshl_or_b32 v76, v46, 24, v76
    v_lshlrev_b32 v78, 7, v87
    v_lshl_or_b32 v78, v47, 24, v78
    v_and_b32 v65, 0xffff, v88
    v_lshrrev_b32 v67, 16, v88
    v_and_b32 v69, 0xffff, v89
    v_lshrrev_b32 v71, 16, v89
    v_and_b32 v73, 0xffff, v90
    v_lshrrev_b32 v75, 16, v90
    v_and_b32 v77, 0xffff, v91
    v_lshrrev_b32 v79, 16, v91
    s_waitcnt lgkmcnt(0)
    v_add_lshl_u32 v8, v8, v48, 3
    v_add_lshl_u32 v9, v9, v49, 3
    v_add_lshl_u32 v10, v10, v50, 3
    v_add_lshl_u32 v11, v11, v51, 3
    v_add_lshl_u32 v12, v12, v52, 3
    v_add_lshl_u32 v13, v13, v53, 3
    v_add_lshl_u32 v14, v14, v54, 3
    v_add_lshl_u32 v15, v15, v55, 3
    ds_write_b64 v8, v[64:65] offset:2048
    ds_write_b64 v9, v[66:67] offset:2048
    ds_write_b64 v10, v[68:69] offset:2048
    ds_write_b64 v11, v[70:71] offset:2048
    ds_write_b64 v12, v[72:73] offset:2048
    ds_write_b64 v13, v[74:75] offset:2048
    ds_write_b64 v14, v[76:77] offset:2048
    ds_write_b64 v15, v[78:79] offset:2048
    s_waitcnt lgkmcnt(0)
    s_barrier
    ds_read_b128 v[8:11], v1 offset:2048
    ds_read_b128 v[12:15], v1 offset:8448
    ds_read_b128 v[16:19], v1 offset:14848
    ds_read_b128 v[20:23], v1 offset:21248
    s_mul_i32 s24, s2, 25600
    v_add_u32 v24, s24, v1
    v_add_u32 v25, 6400, v24
    v_add_u32 v26, 12800, v24
    v_add_u32 v27, 19200, v24
    s_waitcnt lgkmcnt(3)
    global_store_dwordx4 v24, v[8:11], s[10:11] sc0 sc1
    s_waitcnt lgkmcnt(2)
    global_store_dwordx4 v25, v[12:15], s[10:11] sc0 sc1
    s_waitcnt lgkmcnt(1)
    global_store_dwordx4 v26, v[16:19], s[10:11] sc0 sc1
    s_waitcnt lgkmcnt(0)
    global_store_dwordx4 v27, v[20:23], s[10:11] sc0 sc1
    s_endpgm
K1_PREP:
    s_sub_u32 s16, s2, 250
    s_and_b32 s30, s16, 1
    s_lshr_b32 s16, s16, 1
    s_mov_b32 s26, 1.0
    s_cmp_eq_u32 s16, 0
    s_cbranch_scc1 K1_P0
    s_cmp_eq_u32 s16, 1
    s_cbranch_scc1 K1_P1
    s_cmp_eq_u32 s16, 2
    s_cbranch_scc1 K1_P2
    s_load_dwordx2 s[24:25], s[0:1], 56
    s_branch K1_PJ
K1_P0:
    s_load_dwordx2 s[24:25], s[0:1], 40
    s_mov_b32 s26, 0xbfb8aa3b
    s_branch K1_PJ
K1_P1:
    s_load_dwordx2 s[24:25], s[0:1], 64
    s_branch K1_PJ
K1_P2:
    s_load_dwordx2 s[24:25], s[0:1], 32
    s_mov_b32 s26, 0xbfb8aa3b
K1_PJ:
    s_load_dwordx2 s[28:29], s[0:1], 48
    s_lshl_b32 s31, s30, 8
    v_add_u32 v9, s31, v0
    v_and_b32 v1, 63, v9
    v_lshrrev_b32 v2, 6, v9
    v_and_b32 v3, 31, v1
    v_lshrrev_b32 v4, 5, v1
    v_lshrrev_b32 v5, 1, v2
    v_and_b32 v6, 1, v2
    v_lshlrev_b32 v7, 11, v5
    v_lshl_add_u32 v7, v4, 10, v7
    v_lshl_add_u32 v7, v6, 6, v7
    v_lshl_add_u32 v7, v3, 1, v7
    s_lshl_b32 s17, s16, 13
    s_add_u32 s17, s17, 7864320
    v_lshlrev_b32 v8, 4, v9
    v_add_u32 v8, s17, v8
    s_waitcnt lgkmcnt(0)
    v_cmp_gt_u32 vcc, 256, v0
    s_and_saveexec_b64 s[18:19], vcc
    s_cbranch_execz K1_PWC
    global_load_ushort v10, v7, s[24:25] offset:0
    global_load_ushort v11, v7, s[24:25] offset:128
    global_load_ushort v12, v7, s[24:25] offset:256
    global_load_ushort v13, v7, s[24:25] offset:384
    global_load_ushort v14, v7, s[24:25] offset:512
    global_load_ushort v15, v7, s[24:25] offset:640
    global_load_ushort v16, v7, s[24:25] offset:768
    global_load_ushort v17, v7, s[24:25] offset:896
    s_waitcnt vmcnt(0)
    v_lshlrev_b32 v10, 16, v10
    v_mul_f32 v10, s26, v10
    v_lshlrev_b32 v11, 16, v11
    v_mul_f32 v11, s26, v11
    v_lshlrev_b32 v12, 16, v12
    v_mul_f32 v12, s26, v12
    v_lshlrev_b32 v13, 16, v13
    v_mul_f32 v13, s26, v13
    v_lshlrev_b32 v14, 16, v14
    v_mul_f32 v14, s26, v14
    v_lshlrev_b32 v15, 16, v15
    v_mul_f32 v15, s26, v15
    v_lshlrev_b32 v16, 16, v16
    v_mul_f32 v16, s26, v16
    v_lshlrev_b32 v17, 16, v17
    v_mul_f32 v17, s26, v17
    v_cvt_pk_bf16_f32 v20, v10, v11
    v_cvt_pk_bf16_f32 v21, v12, v13
    v_cvt_pk_bf16_f32 v22, v14, v15
    v_cvt_pk_bf16_f32 v23, v16, v17
    global_store_dwordx4 v8, v[20:23], s[10:11]
K1_PWC:
    s_mov_b64 exec, s[18:19]
    s_or_b32 s17, s16, s30
    s_cmp_lg_u32 s17, 0
    s_cbranch_scc1 K1_END
    v_subrev_u32 v9, 256, v0
    v_and_b32 v3, 31, v9
    v_bfe_u32 v4, v9, 5, 1
    v_cmp_gt_u32 vcc, 128, v9
    s_and_saveexec_b64 s[18:19], vcc
    s_cbranch_execz K1_END
    v_lshrrev_b32 v6, 6, v9
    v_lshlrev_b32 v7, 6, v6
    v_lshl_add_u32 v7, v3, 1, v7
    global_load_ushort v10, v7, s[28:29]
    v_lshlrev_b32 v8, 2, v9
    v_add_u32 v8, 7897088, v8
    v_mov_b32 v12, 0x71800000
    s_waitcnt vmcnt(0)
    v_lshlrev_b32 v10, 16, v10
    v_mul_f32 v10, 0xbfb8aa3b, v10
    v_cvt_pk_bf16_f32 v11, v10, v12
    v_cmp_eq_u32 vcc, 0, v4
    s_nop 1
    v_cndmask_b32 v11, 0, v11, vcc
    global_store_dword v8, v11, s[10:11]
K1_END:
    s_endpgm
.globl k2_kernel
.p2align 8
.type k2_kernel,@function
k2_kernel:
    s_cmp_ge_u32 s2, 256
    s_cbranch_scc1 K2_END
    s_load_dwordx2 s[6:7], s[0:1], 88
    s_load_dwordx2 s[4:5], s[0:1], 0
    s_load_dwordx2 s[8:9], s[0:1], 72
    s_and_b32 s28, s2, 7
    s_lshl_b32 s28, s28, 5
    s_lshr_b32 s3, s2, 3
    s_add_u32 s28, s28, s3
    s_mul_i32 s33, s28, 98
    s_sub_u32 s34, 25000, s33
    s_min_u32 s34, s34, 98
    v_lshrrev_b32 v2, 6, v0
    v_and_b32 v1, 63, v0
    v_readfirstlane_b32 s29, v2
    s_mov_b32 s45, 0x3fffff
    s_mov_b32 s46, 0x3fb8
    s_mov_b32 s37, 0
    s_lshl_b32 s3, s33, 7
    s_lshl_b32 s49, s34, 7
    v_lshrrev_b32 v2, 2, v0
    v_lshlrev_b32 v3, 10, v2
    s_lshl_b32 s48, s28, 2
    s_add_u32 s48, s48, 7340032
    v_add_u32 v3, s48, v3
    v_add_u32 v4, 131072, v3
    s_waitcnt lgkmcnt(0)
    s_mov_b32 s24, s6
    s_mov_b32 s25, s7
    s_mov_b32 s26, 33554432
    s_mov_b32 s27, 0x00020000
    buffer_load_dword v16, v3, s[24:27], 0 offen
    buffer_load_dword v17, v4, s[24:27], 0 offen
    s_mov_b32 s12, s4
    s_mov_b32 s13, s5
    s_mov_b32 s14, 3200000
    s_mov_b32 s15, 0x00020000
    s_add_u32 s16, s4, s3
    s_addc_u32 s17, s5, 0
    s_mov_b32 s18, s49
    s_mov_b32 s19, 0x00020000
    s_add_u32 s20, s8, s3
    s_addc_u32 s21, s9, 0
    s_mov_b32 s22, s49
    s_mov_b32 s23, 0x00020000
    s_barrier
    s_lshr_b32 s50, s29, 1
    s_and_b32 s51, s29, 1
    v_and_b32 v14, 31, v1
    v_lshrrev_b32 v15, 5, v1
    v_lshrrev_b32 v22, 4, v1
    v_and_b32 v11, 7, v1
    v_xor_b32 v10, v22, v11
    v_lshlrev_b32 v10, 4, v10
    v_xor_b32 v11, 64, v10
    s_lshl_b32 s3, s29, 12
    s_add_u32 s47, s3, 123008
    s_add_u32 s48, s3, 62720
    s_mov_b32 m0, s48
    v_lshlrev_b32 v3, 4, v1
    s_add_u32 s3, s3, 7864320
    v_add_u32 v3, s3, v3
    buffer_load_dwordx4 v3, s[24:27], 0 offen offset:0 lds
    buffer_load_dwordx4 v3, s[24:27], 0 offen offset:1024 lds
    buffer_load_dwordx4 v3, s[24:27], 0 offen offset:2048 lds
    buffer_load_dwordx4 v3, s[24:27], 0 offen offset:3072 lds
    s_lshl_b32 s3, s29, 11
    s_add_u32 s48, s3, 30976
    s_mov_b32 m0, s48
    v_lshrrev_b32 v22, 3, v1
    v_lshlrev_b32 v22, 7, v22
    v_add_u32 v22, s3, v22
    v_add_u32 v3, v22, v10
    v_add_u32 v4, v22, v11
    v_add_u32 v4, 1024, v4
    buffer_load_dwordx4 v3, s[16:19], 0 offen lds
    s_add_u32 m0, m0, 1024
    v_lshlrev_b32 v7, 2, v1
    buffer_load_dwordx4 v4, s[16:19], 0 offen lds
    v_add_u32 v7, 7897088, v7
    buffer_load_dword a82, v7, s[24:27], 0 offen
    buffer_load_dword a86, v7, s[24:27], 0 offen offset:256
    v_bfe_u32 v22, v14, 1, 3
    v_xor_b32 v22, v22, v15
    v_lshlrev_b32 v22, 4, v22
    v_lshl_add_u32 v22, v14, 7, v22
    v_add_u32 v2, s47, v22
    v_xor_b32 v3, 32, v2
    v_xor_b32 v4, 64, v2
    v_xor_b32 v5, 96, v2
    v_bfe_u32 v22, v1, 4, 1
    v_and_b32 v12, 3, v1
    v_lshlrev_b32 v12, 3, v12
    v_lshl_add_u32 v12, v22, 5, v12
    v_lshlrev_b32 v13, 2, v14
    v_lshrrev_b32 v40, 3, v14
    v_bfe_u32 v41, v14, 2, 1
    v_cmp_eq_u32 vcc, v41, v15
    v_mov_b32 v42, 0x3f80
    v_and_b32 v43, 1, v40
    v_cndmask_b32 v42, 0, v42, vcc
    v_lshlrev_b32 v43, 4, v43
    v_lshlrev_b32 v42, v43, v42
    v_cmp_gt_u32 vcc, 2, v40
    v_mov_b32 v45, 0
    s_nop 0
    v_cndmask_b32 v43, 0, v42, vcc
    v_cndmask_b32 v44, v42, 0, vcc
    v_accvgpr_write_b32 a88, v43
    v_accvgpr_write_b32 a89, v44
    v_accvgpr_write_b32 a91, v45
    v_accvgpr_write_b32 a83, v45
    v_accvgpr_write_b32 a87, v45
K2_ROUND_INIT:
    v_lshlrev_b32 v40, 2, v0
    v_mov_b32 v41, 0
    v_cmp_gt_u32 vcc, 192, v0
    s_and_saveexec_b64 s[52:53], vcc
    ds_write_b32 v40, v41 offset:16384
    v_cmp_gt_u32 vcc, 18, v0
    s_and_b64 exec, exec, vcc
    v_cmp_gt_u32 vcc, 16, v0
    v_mov_b32 v42, -1
    s_nop 0
    v_cndmask_b32 v42, 0, v42, vcc
    ds_write_b32 v40, v42 offset:18432
    s_mov_b64 exec, s[52:53]
    v_and_b32 v22, 3, v0
    v_lshlrev_b32 v22, 1, v22
    s_cmp_lg_u32 s37, 0
    s_cbranch_scc1 K2_ROUND_N
    v_lshrrev_b32 v40, 2, v0
    v_add_u32 v41, 128, v40
    v_cmp_gt_u32 vcc, 250, v41
    v_mul_u32_u24 v40, 3200, v40
    v_mul_u32_u24 v41, 3200, v41
    v_add_u32 v40, v40, v22
    v_add_u32 v41, v41, v22
    s_waitcnt vmcnt(8)
    v_and_b32 v42, 0xffff, v16
    v_lshrrev_b32 v43, 16, v16
    v_and_b32 v44, 0xffff, v17
    v_lshrrev_b32 v45, 16, v17
    v_sub_u32 v30, v43, v42
    v_sub_u32 v31, v45, v44
    v_add_lshl_u32 v32, v40, v42, 3
    v_add_lshl_u32 v33, v41, v44, 3
    v_cndmask_b32 v31, 0, v31, vcc
K2_ROUND_N:
    v_min_u32 v18, 32, v30
    v_min_u32 v19, 32, v31
    v_sub_u32 v20, v18, v22
    v_sub_u32 v21, v19, v22
    v_cmp_lt_i32 s[56:57], 0, v20
    v_cmp_lt_i32 s[58:59], 1, v20
    v_cmp_lt_i32 s[60:61], 0, v21
    v_cmp_lt_i32 s[62:63], 1, v21
    v_cmp_lt_i32 s[64:65], 8, v20
    v_cmp_lt_i32 s[66:67], 9, v20
    v_cmp_lt_i32 s[68:69], 8, v21
    v_cmp_lt_i32 s[70:71], 9, v21
    v_cmp_lt_i32 s[72:73], 16, v20
    v_cmp_lt_i32 s[74:75], 17, v20
    v_cmp_lt_i32 s[76:77], 16, v21
    v_cmp_lt_i32 s[78:79], 17, v21
    v_cmp_lt_i32 s[80:81], 24, v20
    v_cmp_lt_i32 s[82:83], 25, v20
    v_cmp_lt_i32 s[84:85], 24, v21
    v_cmp_lt_i32 s[86:87], 25, v21
    s_mov_b32 s39, 2
    s_or_b64 s[52:53], s[72:73], s[76:77]
    s_cmp_lg_u64 s[52:53], 0
    s_cselect_b32 s39, 3, s39
    s_or_b64 s[52:53], s[80:81], s[84:85]
    s_cmp_lg_u64 s[52:53], 0
    s_cselect_b32 s39, 4, s39
    s_cmp_lg_u32 s37, 0
    s_cbranch_scc1 K2_LATER
    s_mov_b64 exec, s[56:57]
    buffer_load_dwordx4 v[64:67], v32, s[24:27], 0 offen offset:0
    s_mov_b64 exec, s[60:61]
    buffer_load_dwordx4 v[68:71], v33, s[24:27], 0 offen offset:0
    s_mov_b64 exec, s[64:65]
    buffer_load_dwordx4 v[72:75], v32, s[24:27], 0 offen offset:64
    s_mov_b64 exec, s[68:69]
    buffer_load_dwordx4 v[76:79], v33, s[24:27], 0 offen offset:64
    s_mov_b64 exec, s[72:73]
    buffer_load_dwordx4 v[80:83], v32, s[24:27], 0 offen offset:128
    s_mov_b64 exec, s[76:77]
    buffer_load_dwordx4 v[84:87], v33, s[24:27], 0 offen offset:128
    s_mov_b64 exec, s[80:81]
    buffer_load_dwordx4 v[88:91], v32, s[24:27], 0 offen offset:192
    s_mov_b64 exec, s[84:85]
    buffer_load_dwordx4 v[92:95], v33, s[24:27], 0 offen offset:192
    s_mov_b64 exec, -1
    s_waitcnt vmcnt(8) lgkmcnt(0)
    s_barrier
    s_lshl_b32 s3, s50, 12
    s_add_u32 s3, s3, 30976
    s_sub_u32 s3, s3, s47
    v_add_u32 v60, s3, v2
    v_add_u32 v61, s3, v3
    v_add_u32 v62, s3, v4
    v_add_u32 v63, s3, v5
    v_lshlrev_b32 v22, 4, v1
    s_lshl_b32 s3, s51, 10
    s_add_u32 s3, s3, 62720
    v_add_u32 v23, s3, v22
    ds_read_b128 v[40:43], v60
    ds_read_b128 v[44:47], v61
    ds_read_b128 v[48:51], v62
    ds_read_b128 v[52:55], v63
    ds_read_b128 a[112:115], v23 offset:16384
    ds_read_b128 a[116:119], v23 offset:18432
    ds_read_b128 a[120:123], v23 offset:20480
    ds_read_b128 a[124:127], v23 offset:22528
    ds_read_b128 a[64:67], v23 offset:24576
    ds_read_b128 a[68:71], v23 offset:26624
    ds_read_b128 a[72:75], v23 offset:28672
    ds_read_b128 a[76:79], v23 offset:30720
    s_lshl_b32 s3, s50, 12
    s_lshl_b32 s49, s51, 6
    s_add_u32 s3, s3, s49
    v_and_b32 v22, 7, v14
    v_xor_b32 v22, v22, v15
    v_lshlrev_b32 v22, 3, v22
    v_lshl_add_u32 v22, v14, 7, v22
    v_add_u32 v60, s3, v22
    v_xor_b32 v61, 16, v60
    v_xor_b32 v62, 32, v60
    v_xor_b32 v63, 48, v60
    s_waitcnt lgkmcnt(4)
    v_mfma_f32_32x32x16_bf16 v[96:111], a[112:115], v[40:43], 0
    v_mfma_f32_32x32x16_bf16 v[96:111], a[116:119], v[44:47], v[96:111]
    v_mfma_f32_32x32x16_bf16 v[96:111], a[120:123], v[48:51], v[96:111]
    v_mfma_f32_32x32x16_bf16 v[96:111], a[124:127], v[52:55], v[96:111]
    s_waitcnt lgkmcnt(0)
    v_mfma_f32_32x32x16_bf16 a[96:111], a[64:67], v[40:43], 0
    v_mfma_f32_32x32x16_bf16 a[96:111], a[68:71], v[44:47], a[96:111]
    v_mfma_f32_32x32x16_bf16 a[96:111], a[72:75], v[48:51], a[96:111]
    v_mfma_f32_32x32x16_bf16 a[96:111], a[76:79], v[52:55], a[96:111]
    s_nop 7
    v_cvt_pk_bf16_f32 v48, v96, v97
    v_cvt_pk_bf16_f32 v49, v98, v99
    v_cvt_pk_bf16_f32 v50, v100, v101
    v_cvt_pk_bf16_f32 v51, v102, v103
    v_cvt_pk_bf16_f32 v52, v104, v105
    v_cvt_pk_bf16_f32 v53, v106, v107
    v_cvt_pk_bf16_f32 v54, v108, v109
    v_cvt_pk_bf16_f32 v55, v110, v111
    ds_write_b64 v60, v[48:49] offset:0
    ds_write_b64 v61, v[50:51] offset:0
    ds_write_b64 v62, v[52:53] offset:0
    ds_write_b64 v63, v[54:55] offset:0
    s_branch K2_COUNT0
K2_LATER:
    s_mov_b64 exec, s[56:57]
    buffer_load_dwordx4 v[64:67], v32, s[24:27], 0 offen offset:0
    s_mov_b64 exec, s[60:61]
    buffer_load_dwordx4 v[68:71], v33, s[24:27], 0 offen offset:0
    s_mov_b64 exec, s[64:65]
    buffer_load_dwordx4 v[72:75], v32, s[24:27], 0 offen offset:64
    s_mov_b64 exec, s[68:69]
    buffer_load_dwordx4 v[76:79], v33, s[24:27], 0 offen offset:64
    s_mov_b64 exec, s[72:73]
    buffer_load_dwordx4 v[80:83], v32, s[24:27], 0 offen offset:128
    s_mov_b64 exec, s[76:77]
    buffer_load_dwordx4 v[84:87], v33, s[24:27], 0 offen offset:128
    s_mov_b64 exec, s[80:81]
    buffer_load_dwordx4 v[88:91], v32, s[24:27], 0 offen offset:192
    s_mov_b64 exec, s[84:85]
    buffer_load_dwordx4 v[92:95], v33, s[24:27], 0 offen offset:192
    s_mov_b64 exec, -1
K2_SKIPW:
    s_waitcnt vmcnt(0) lgkmcnt(0)
    s_barrier
K2_COUNT0:
K2_COUNT:
    v_mov_b32 v40, 1
    s_waitcnt vmcnt(6)
    v_lshrrev_b32 v96, 22, v64
    v_lshrrev_b32 v97, 22, v66
    v_lshrrev_b32 v98, 22, v68
    v_lshrrev_b32 v99, 22, v70
    s_mov_b64 exec, s[56:57]
    ds_add_rtn_u32 v112, v96, v40 offset:16384
    s_mov_b64 exec, s[58:59]
    ds_add_rtn_u32 v113, v97, v40 offset:16384
    s_mov_b64 exec, s[60:61]
    ds_add_rtn_u32 v114, v98, v40 offset:16384
    s_mov_b64 exec, s[62:63]
    ds_add_rtn_u32 v115, v99, v40 offset:16384

    s_mov_b64 exec, -1
    s_waitcnt vmcnt(4)
    v_lshrrev_b32 v100, 22, v72
    v_lshrrev_b32 v101, 22, v74
    v_lshrrev_b32 v102, 22, v76
    v_lshrrev_b32 v103, 22, v78
    s_mov_b64 exec, s[64:65]
    ds_add_rtn_u32 v116, v100, v40 offset:16384
    s_mov_b64 exec, s[66:67]
    ds_add_rtn_u32 v117, v101, v40 offset:16384
    s_mov_b64 exec, s[68:69]
    ds_add_rtn_u32 v118, v102, v40 offset:16384
    s_mov_b64 exec, s[70:71]
    ds_add_rtn_u32 v119, v103, v40 offset:16384

    s_mov_b64 exec, -1
    s_cmp_le_u32 s39, 2
    s_cbranch_scc1 K2_CNT_DONE
    s_waitcnt vmcnt(2)
    v_lshrrev_b32 v104, 22, v80
    v_lshrrev_b32 v105, 22, v82
    v_lshrrev_b32 v106, 22, v84
    v_lshrrev_b32 v107, 22, v86
    s_mov_b64 exec, s[72:73]
    ds_add_rtn_u32 v120, v104, v40 offset:16384
    s_mov_b64 exec, s[74:75]
    ds_add_rtn_u32 v121, v105, v40 offset:16384
    s_mov_b64 exec, s[76:77]
    ds_add_rtn_u32 v122, v106, v40 offset:16384
    s_mov_b64 exec, s[78:79]
    ds_add_rtn_u32 v123, v107, v40 offset:16384

    s_mov_b64 exec, -1
    s_cmp_le_u32 s39, 3
    s_cbranch_scc1 K2_CNT_DONE
    s_waitcnt vmcnt(0)
    v_lshrrev_b32 v108, 22, v88
    v_lshrrev_b32 v109, 22, v90
    v_lshrrev_b32 v110, 22, v92
    v_lshrrev_b32 v111, 22, v94
    s_mov_b64 exec, s[80:81]
    ds_add_rtn_u32 v124, v108, v40 offset:16384
    s_mov_b64 exec, s[82:83]
    ds_add_rtn_u32 v125, v109, v40 offset:16384
    s_mov_b64 exec, s[84:85]
    ds_add_rtn_u32 v126, v110, v40 offset:16384
    s_mov_b64 exec, s[86:87]
    ds_add_rtn_u32 v127, v111, v40 offset:16384

    s_mov_b64 exec, -1
K2_CNT_DONE:
    s_mov_b64 exec, -1
    s_waitcnt lgkmcnt(0)
    s_barrier
    v_lshlrev_b32 v40, 3, v1
    ds_read_b64 v[42:43], v40 offset:16384
    s_waitcnt lgkmcnt(0)
    v_add_u32 v44, 3, v42
    v_add_u32 v45, 3, v43
    v_lshrrev_b32 v44, 2, v44
    v_lshrrev_b32 v45, 2, v45
    v_add_u32 v46, v44, v45
    v_mov_b32 v47, v46
    s_nop 1
    v_add_u32_dpp v47, v47, v47 row_shr:1 row_mask:0xf bank_mask:0xf
    s_nop 1
    v_add_u32_dpp v47, v47, v47 row_shr:2 row_mask:0xf bank_mask:0xf
    s_nop 1
    v_add_u32_dpp v47, v47, v47 row_shr:4 row_mask:0xf bank_mask:0xf
    s_nop 1
    v_add_u32_dpp v47, v47, v47 row_shr:8 row_mask:0xf bank_mask:0xf
    s_nop 1
    v_add_u32_dpp v47, v47, v47 row_bcast:15 row_mask:0xa bank_mask:0xf
    s_nop 1
    v_add_u32_dpp v47, v47, v47 row_bcast:31 row_mask:0xc bank_mask:0xf
    v_sub_u32 v48, v47, v46
    v_add_u32 v49, v48, v44
    v_readlane_b32 s36, v47, 63
    v_lshlrev_b32 v50, 5, v48
    v_lshlrev_b32 v51, 5, v49
    v_add_u32 v50, 30976, v50
    v_add_u32 v51, 30976, v51
    s_cmp_le_u32 s36, 960
    s_cbranch_scc1 K2_FITS
    s_barrier
    v_lshlrev_b32 v40, 2, v0
    v_mov_b32 v41, 0
    v_cmp_gt_u32 vcc, 192, v0
    s_and_saveexec_b64 s[52:53], vcc
    ds_write_b32 v40, v41 offset:16384
    s_mov_b64 exec, s[52:53]
    v_min_u32 v18, 12, v30
    v_min_u32 v19, 12, v31
    v_and_b32 v22, 3, v0
    v_lshlrev_b32 v22, 1, v22
    v_sub_u32 v20, v18, v22
    v_sub_u32 v21, v19, v22
    v_cmp_lt_i32 s[56:57], 0, v20
    v_cmp_lt_i32 s[58:59], 1, v20
    v_cmp_lt_i32 s[60:61], 0, v21
    v_cmp_lt_i32 s[62:63], 1, v21
    v_cmp_lt_i32 s[64:65], 8, v20
    v_cmp_lt_i32 s[66:67], 9, v20
    v_cmp_lt_i32 s[68:69], 8, v21
    v_cmp_lt_i32 s[70:71], 9, v21
    v_cmp_lt_i32 s[72:73], 16, v20
    v_cmp_lt_i32 s[74:75], 17, v20
    v_cmp_lt_i32 s[76:77], 16, v21
    v_cmp_lt_i32 s[78:79], 17, v21
    v_cmp_lt_i32 s[80:81], 24, v20
    v_cmp_lt_i32 s[82:83], 25, v20
    v_cmp_lt_i32 s[84:85], 24, v21
    v_cmp_lt_i32 s[86:87], 25, v21
    s_mov_b32 s39, 2
    s_or_b64 s[52:53], s[72:73], s[76:77]
    s_cmp_lg_u64 s[52:53], 0
    s_cselect_b32 s39, 3, s39
    s_or_b64 s[52:53], s[80:81], s[84:85]
    s_cmp_lg_u64 s[52:53], 0
    s_cselect_b32 s39, 4, s39
    s_waitcnt lgkmcnt(0)
    s_barrier
    s_branch K2_COUNT
K2_FITS:
    ds_write_b64 v40, v[48:49] offset:17152
    ds_write_b64 v40, v[50:51] offset:17664
    s_add_u32 s3, s36, 31
    s_lshr_b32 s3, s3, 5
    s_max_u32 s3, s3, 2
    s_add_u32 s40, s3, 1
    s_lshr_b32 s40, s40, 1
    s_lshr_b32 s41, s3, 1
    s_cmp_lt_u32 s29, 4
    s_cselect_b32 s30, s40, s41
    s_lshl_b32 s40, s40, 2
    s_lshl_b32 s41, s41, 2
    s_sub_u32 s42, s40, s41
    s_lshl_b32 s42, s42, 3
    s_lshl_b32 s43, s3, 5
    v_cvt_f32_u32 v52, s40
    v_cvt_f32_u32 v34, s41
    v_rcp_f32 v52, v52
    v_rcp_f32 v34, v34
    s_lshl_b32 s3, s40, 3
    v_cvt_f32_u32 v35, s3
    v_sub_f32 v35, 0.5, v35
    v_mov_b32 v36, 0x41000000
    v_fma_f32 v35, v35, v34, v36
    v_lshrrev_b32 v54, 2, v0
    v_lshlrev_b32 v40, 2, v54
    v_mul_f32 v53, 0.5, v52
    s_waitcnt lgkmcnt(0)
    ds_read_b32 v42, v40 offset:17152
    ds_read_b32 v43, v40 offset:17156
    ds_read_b32 v44, v40 offset:16384
    s_mov_b64 exec, s[56:57]
    ds_read_b32 v96, v96 offset:17664
    s_mov_b64 exec, s[58:59]
    ds_read_b32 v97, v97 offset:17664
    s_mov_b64 exec, s[60:61]
    ds_read_b32 v98, v98 offset:17664
    s_mov_b64 exec, s[62:63]
    ds_read_b32 v99, v99 offset:17664
    s_mov_b64 exec, s[64:65]
    ds_read_b32 v100, v100 offset:17664
    s_mov_b64 exec, s[66:67]
    ds_read_b32 v101, v101 offset:17664
    s_mov_b64 exec, s[68:69]
    ds_read_b32 v102, v102 offset:17664
    s_mov_b64 exec, s[70:71]
    ds_read_b32 v103, v103 offset:17664
    s_cmp_le_u32 s39, 2
    s_cbranch_scc1 K2_S1_DONE
    s_mov_b64 exec, s[72:73]
    ds_read_b32 v104, v104 offset:17664
    s_mov_b64 exec, s[74:75]
    ds_read_b32 v105, v105 offset:17664
    s_mov_b64 exec, s[76:77]
    ds_read_b32 v106, v106 offset:17664
    s_mov_b64 exec, s[78:79]
    ds_read_b32 v107, v107 offset:17664
    s_cmp_le_u32 s39, 3
    s_cbranch_scc1 K2_S1_DONE
    s_mov_b64 exec, s[80:81]
    ds_read_b32 v108, v108 offset:17664
    s_mov_b64 exec, s[82:83]
    ds_read_b32 v109, v109 offset:17664
    s_mov_b64 exec, s[84:85]
    ds_read_b32 v110, v110 offset:17664
    s_mov_b64 exec, s[86:87]
    ds_read_b32 v111, v111 offset:17664
K2_S1_DONE:
    s_mov_b64 exec, -1
    v_cmp_gt_u32 vcc, v30, v18
    v_cmp_gt_u32 s[52:53], v31, v19
    v_and_b32 v45, 3, v0
    s_nop 0
    s_or_b64 vcc, vcc, s[52:53]
    s_and_saveexec_b64 s[52:53], vcc
    v_mov_b32 v46, 1
    v_mov_b32 v47, 18496
    ds_write_b32 v47, v46
    s_mov_b64 exec, s[52:53]
    v_cmp_gt_u32 vcc, 98, v54
    s_and_b64 exec, exec, vcc
    s_cbranch_execz K2_NODE_DONE
    v_lshlrev_b32 v46, 7, v54
    v_and_b32 v47, 7, v54
    v_lshl_or_b32 v46, v47, 3, v46
    v_mul_u32_u24 v47, 528, v54
    v_add_u32 v47, 62720, v47
    s_mov_b64 s[54:55], exec
    s_waitcnt lgkmcnt(0)
    v_sub_u32 v43, v43, v42
    v_cmp_eq_u32 vcc, 0, v44
    s_and_b64 exec, exec, vcc
    v_mov_b32 v48, 1
    v_mov_b32 v49, 18500
    ds_write_b32 v49, v48
    s_mov_b64 exec, s[54:55]
    v_add_u32 v48, v44, v45
    v_lshlrev_b32 v49, 2, v43
    v_cmp_lt_u32 vcc, v48, v49
    v_lshlrev_b32 v49, 5, v42
    v_lshl_add_u32 v49, v48, 3, v49
    v_mov_b32 v50, 0
    v_mov_b32 v51, 0x3f800000
    s_and_b64 exec, exec, vcc
    ds_write_b64 v49, v[50:51] offset:30976
    s_mov_b64 exec, s[54:55]
    v_add_u32 v48, v42, v43
    v_max_u32 v49, 1, v43
    v_add_u32 v49, v42, v49
    v_subrev_u32 v49, 1, v49
    s_lshl_b32 s3, s40, 3
    v_cvt_f32_u32 v50, v42
    v_cvt_f32_u32 v51, v49
    v_fma_f32 v55, v50, v34, v35
    v_fma_f32 v56, v51, v34, v35
    v_fma_f32 v50, v50, v52, v53
    v_fma_f32 v51, v51, v52, v53
    v_cmp_gt_u32 vcc, s3, v42
    v_cmp_gt_u32 s[52:53], s3, v49
    v_cvt_u32_f32 v55, v55
    v_cvt_u32_f32 v56, v56
    v_cvt_u32_f32 v50, v50
    v_cvt_u32_f32 v51, v51
    v_cndmask_b32 v50, v55, v50, vcc
    v_cndmask_b32 v51, v56, v51, s[52:53]
    v_add_u32 v55, 1, v50
    v_mul_u32_u24 v56, s40, v55
    v_mul_u32_u24 v57, s41, v55
    v_add_u32 v57, s42, v57
    v_min_u32 v56, v56, v57
    v_mul_u32_u24 v57, 528, v55
    v_add_u32 v57, 114464, v57
    v_cmp_lt_u32 vcc, v50, v51
    v_lshlrev_b32 v58, 2, v55
    s_and_b64 exec, exec, vcc
    ds_write_b32 v58, v54 offset:18432
    s_mov_b64 exec, s[54:55]
    v_add_u32 v59, v42, v45
    v_mov_b32 v60, 1.0
    v_mov_b32 v61, 0
    v_cmp_lt_u32 vcc, v59, v48
    s_and_b64 exec, exec, vcc
    v_cmp_ge_u32 vcc, v59, v56
    v_cmp_eq_u32 s[52:53], v59, v56
    v_cmp_eq_u32 s[88:89], v59, v42
    v_lshlrev_b32 v62, 2, v59
    v_cndmask_b32 v63, v47, v57, vcc
    s_or_b64 s[52:53], s[52:53], s[88:89]
    ds_write2st64_b32 v62, v46, v63 offset0:73 offset1:89
    v_cndmask_b32 v63, v60, v61, s[52:53]
    v_add_u32 v59, 4, v59
    ds_write_b32 v62, v63 offset:26880
    v_cmp_lt_u32 vcc, v59, v48
    s_and_b64 exec, exec, vcc
    v_cmp_ge_u32 vcc, v59, v56
    v_cmp_eq_u32 s[52:53], v59, v56
    v_cmp_eq_u32 s[88:89], v59, v42
    v_lshlrev_b32 v62, 2, v59
    v_cndmask_b32 v63, v47, v57, vcc
    s_or_b64 s[52:53], s[52:53], s[88:89]
    ds_write2st64_b32 v62, v46, v63 offset0:73 offset1:89
    v_cndmask_b32 v63, v60, v61, s[52:53]
    v_add_u32 v59, 4, v59
    ds_write_b32 v62, v63 offset:26880
    v_cmp_lt_u32 vcc, v59, v48
    s_and_b64 exec, exec, vcc
    v_cmp_ge_u32 vcc, v59, v56
    v_cmp_eq_u32 s[52:53], v59, v56
    v_cmp_eq_u32 s[88:89], v59, v42
    v_lshlrev_b32 v62, 2, v59
    v_cndmask_b32 v63, v47, v57, vcc
    s_or_b64 s[52:53], s[52:53], s[88:89]
    ds_write2st64_b32 v62, v46, v63 offset0:73 offset1:89
    v_cndmask_b32 v63, v60, v61, s[52:53]
    v_add_u32 v59, 4, v59
    ds_write_b32 v62, v63 offset:26880
    v_cmp_lt_u32 vcc, v59, v48
    s_and_b64 exec, exec, vcc
    v_cmp_ge_u32 vcc, v59, v56
    v_cmp_eq_u32 s[52:53], v59, v56
    v_cmp_eq_u32 s[88:89], v59, v42
    v_lshlrev_b32 v62, 2, v59
    v_cndmask_b32 v63, v47, v57, vcc
    s_or_b64 s[52:53], s[52:53], s[88:89]
    ds_write2st64_b32 v62, v46, v63 offset0:73 offset1:89
    v_cndmask_b32 v63, v60, v61, s[52:53]
    v_add_u32 v59, 4, v59
    ds_write_b32 v62, v63 offset:26880
    s_mov_b64 exec, s[54:55]
    v_cmp_lt_u32 vcc, 16, v43
    v_add_u32 v59, 1, v50
    v_cmp_lt_u32 s[52:53], v59, v51
    s_nop 1
    s_or_b64 vcc, vcc, s[52:53]
    s_cbranch_vccz K2_NODE_DONE
    v_add_lshl_u32 v58, v42, v45, 2
    v_cmp_eq_u32 vcc, 0, v45
    v_mov_b32 v49, v45
    v_mov_b32 v55, 1.0
    v_mov_b32 v59, 0
    v_cndmask_b32 v56, 1.0, v59, vcc
K2_BULK:
    v_cmp_lt_u32 vcc, v49, v43
    s_and_b64 exec, exec, vcc
    s_cbranch_execz K2_BULK_DONE
    ds_write2st64_b32 v58, v46, v47 offset0:73 offset1:89
    ds_write_b32 v58, v56 offset:26880
    v_mov_b32 v56, v55
    v_add_u32 v58, 16, v58
    v_add_u32 v49, 4, v49
    s_branch K2_BULK
K2_BULK_DONE:
    s_mov_b64 exec, s[54:55]
    v_cmp_lt_u32 vcc, 0, v43
    s_and_b64 exec, exec, vcc
    s_cbranch_execz K2_NODE_DONE
K2_BND:
    v_cmp_lt_u32 vcc, v50, v51
    s_and_b64 exec, exec, vcc
    s_cbranch_execz K2_NODE_DONE
    v_add_u32 v50, 1, v50
    v_mul_u32_u24 v55, s40, v50
    v_mul_u32_u24 v56, s41, v50
    v_add_u32 v56, s42, v56
    v_min_u32 v55, v55, v56
    v_add_u32 v61, 1, v50
    v_mul_u32_u24 v60, s40, v61
    v_mul_u32_u24 v61, s41, v61
    v_add_u32 v61, s42, v61
    v_min_u32 v60, v60, v61
    v_mul_u32_u24 v56, 528, v50
    v_add_u32 v56, 114464, v56
    v_lshlrev_b32 v57, 2, v50
    v_lshlrev_b32 v58, 2, v55
    v_mov_b32 v59, 0
    ds_write_b32 v57, v54 offset:18432
    ds_write_b32 v58, v59 offset:26880
    v_min_u32 v60, v60, v48
    v_add_u32 v55, v55, v45
    s_mov_b64 s[52:53], exec
K2_BND2:
    v_cmp_lt_u32 vcc, v55, v60
    s_and_b64 exec, exec, vcc
    s_cbranch_execz K2_BND2_DONE
    v_lshlrev_b32 v58, 2, v55
    ds_write_b32 v58, v56 offset:22784
    v_add_u32 v55, 4, v55
    s_branch K2_BND2
K2_BND2_DONE:
    s_mov_b64 exec, s[52:53]
    s_branch K2_BND
K2_NODE_DONE:
    s_mov_b64 exec, -1
    s_sub_u32 s3, s43, s36
    s_lshl_b32 s49, s3, 2
    v_cmp_gt_u32 vcc, s49, v0
    s_and_saveexec_b64 s[52:53], vcc
    s_cbranch_execz K2_PADG_DONE
    s_lshl_b32 s48, s36, 5
    v_lshlrev_b32 v48, 3, v0
    v_add_u32 v48, s48, v48
    v_mov_b32 v50, 0
    v_mov_b32 v51, 0x3f800000
    ds_write_b64 v48, v[50:51] offset:30976
    v_cmp_gt_u32 vcc, s3, v0
    s_lshl_b32 s48, s36, 2
    v_lshlrev_b32 v48, 2, v0
    v_add_u32 v48, s48, v48
    v_mov_b32 v51, 114464
    s_and_b64 exec, exec, vcc
    ds_write2st64_b32 v48, v50, v51 offset0:73 offset1:89
    ds_write_b32 v48, v50 offset:26880
K2_PADG_DONE:
    s_mov_b64 exec, s[52:53]
    v_lshlrev_b32 v41, 3, v1
    v_add_u32 v41, 62208, v41
    s_waitcnt lgkmcnt(0)
    v_lshl_add_u32 v96, v112, 3, v96
    v_lshl_add_u32 v97, v113, 3, v97
    v_lshl_add_u32 v98, v114, 3, v98
    v_lshl_add_u32 v99, v115, 3, v99
    v_lshl_add_u32 v100, v116, 3, v100
    v_lshl_add_u32 v101, v117, 3, v101
    v_lshl_add_u32 v102, v118, 3, v102
    v_lshl_add_u32 v103, v119, 3, v103
    s_mov_b64 exec, s[56:57]
    ds_write_b64 v96, v[64:65]
    s_mov_b64 exec, s[58:59]
    ds_write_b64 v97, v[66:67]
    s_mov_b64 exec, s[60:61]
    ds_write_b64 v98, v[68:69]
    s_mov_b64 exec, s[62:63]
    ds_write_b64 v99, v[70:71]
    s_mov_b64 exec, s[64:65]
    ds_write_b64 v100, v[72:73]
    s_mov_b64 exec, s[66:67]
    ds_write_b64 v101, v[74:75]
    s_mov_b64 exec, s[68:69]
    ds_write_b64 v102, v[76:77]
    s_mov_b64 exec, s[70:71]
    ds_write_b64 v103, v[78:79]

    s_mov_b64 exec, -1

    s_mov_b64 exec, -1
    s_cmp_le_u32 s39, 2
    s_cbranch_scc1 K2_S3_DONE
    v_lshl_add_u32 v104, v120, 3, v104
    v_lshl_add_u32 v105, v121, 3, v105
    v_lshl_add_u32 v106, v122, 3, v106
    v_lshl_add_u32 v107, v123, 3, v107
    s_mov_b64 exec, s[72:73]
    ds_write_b64 v104, v[80:81]
    s_mov_b64 exec, s[74:75]
    ds_write_b64 v105, v[82:83]
    s_mov_b64 exec, s[76:77]
    ds_write_b64 v106, v[84:85]
    s_mov_b64 exec, s[78:79]
    ds_write_b64 v107, v[86:87]

    s_mov_b64 exec, -1
    s_cmp_le_u32 s39, 3
    s_cbranch_scc1 K2_S3_DONE
    v_lshl_add_u32 v108, v124, 3, v108
    v_lshl_add_u32 v109, v125, 3, v109
    v_lshl_add_u32 v110, v126, 3, v110
    v_lshl_add_u32 v111, v127, 3, v111
    s_mov_b64 exec, s[80:81]
    ds_write_b64 v108, v[88:89]
    s_mov_b64 exec, s[82:83]
    ds_write_b64 v109, v[90:91]
    s_mov_b64 exec, s[84:85]
    ds_write_b64 v110, v[92:93]
    s_mov_b64 exec, s[86:87]
    ds_write_b64 v111, v[94:95]

    s_mov_b64 exec, -1
K2_S3_DONE:
    s_mov_b64 exec, -1
    v_sub_u32 v30, v30, v18
    v_lshl_add_u32 v32, v18, 3, v32
    v_sub_u32 v31, v31, v19
    v_lshl_add_u32 v33, v19, 3, v33
    s_lshl_b32 s3, s29, 1
    s_mul_i32 s48, s3, s40
    s_mul_i32 s49, s3, s41
    s_add_u32 s49, s49, s42
    s_min_u32 s3, s48, s49
    s_lshl_b32 s48, s3, 5
    s_add_u32 s48, s48, 30976
    s_lshl_b32 s49, s30, 7
    v_mul_u32_u24 v41, s49, v15
    v_add_u32 v41, s48, v41
    v_bfe_u32 v42, v1, 3, 2
    v_lshl_add_u32 v6, v42, 3, v41
    v_bfe_u32 v42, v14, 2, 1
    v_mul_u32_u24 v42, s49, v42
    v_add_u32 v42, s48, v42
    v_lshrrev_b32 v43, 3, v14
    v_lshl_add_u32 v42, v43, 5, v42
    v_and_b32 v43, 3, v14
    v_lshl_add_u32 v42, v43, 3, v42
    v_add_u32 v7, 4, v42
    s_lshl_b32 s48, s3, 2
    s_lshl_b32 s49, s30, 4
    v_mul_u32_u24 v41, s49, v15
    v_add_u32 v41, s48, v41
    v_add_u32 v9, 22784, v41
    v_bfe_u32 v42, v1, 2, 2
    v_lshl_add_u32 v41, v42, 2, v41
    v_add_u32 v8, 18688, v41
    v_mov_b64 v[56:57], 0
    v_mov_b64 v[58:59], 0
    s_waitcnt lgkmcnt(0)
    s_barrier
    ds_read2_b32 v[24:25], v6 offset0:0 offset1:8
    ds_read2_b32 v[26:27], v6 offset0:16 offset1:24
    v_mov_b32 v40, 18500
    ds_read_b32 v41, v40
    s_waitcnt lgkmcnt(0)
    v_and_or_b32 v24, v24, s45, v10
    s_mov_b32 m0, s47
    s_nop 0
    buffer_load_dwordx4 v24, s[12:15], 0 offen lds
    v_and_or_b32 v25, v25, s45, v11
    s_add_u32 m0, m0, 1024
    s_nop 0
    buffer_load_dwordx4 v25, s[12:15], 0 offen lds
    v_and_or_b32 v26, v26, s45, v10
    s_add_u32 m0, m0, 1024
    s_nop 0
    buffer_load_dwordx4 v26, s[12:15], 0 offen lds
    v_and_or_b32 v27, v27, s45, v11
    s_add_u32 m0, m0, 1024
    s_nop 0
    buffer_load_dwordx4 v27, s[12:15], 0 offen lds
    v_add_u32 v6, 128, v6
    v_readfirstlane_b32 s48, v41
    ds_read_b32 v28, v8 offset:0
    ds_read2_b32 v[24:25], v6 offset0:0 offset1:8
    ds_read2_b32 v[26:27], v6 offset0:16 offset1:24
    ds_read_b32 a90, v7 offset:0
    s_cmp_lg_u32 s37, 0
    s_cbranch_scc1 K2_NOW2
    v_lshlrev_b32 v42, 4, v1
    v_add_u32 v42, 62720, v42
    ds_read_b128 a[0:3], v42 offset:0
    ds_read_b128 a[4:7], v42 offset:1024
    ds_read_b128 a[8:11], v42 offset:2048
    ds_read_b128 a[12:15], v42 offset:3072
    ds_read_b128 a[16:19], v42 offset:4096
    ds_read_b128 a[20:23], v42 offset:5120
    ds_read_b128 a[24:27], v42 offset:6144
    ds_read_b128 a[28:31], v42 offset:7168
    ds_read_b128 a[32:35], v42 offset:8192
    ds_read_b128 a[36:39], v42 offset:9216
    ds_read_b128 a[40:43], v42 offset:10240
    ds_read_b128 a[44:47], v42 offset:11264
    ds_read_b128 a[48:51], v42 offset:12288
    ds_read_b128 a[52:55], v42 offset:13312
    ds_read_b128 a[56:59], v42 offset:14336
    ds_read_b128 a[60:63], v42 offset:15360
K2_NOW2:
    s_waitcnt lgkmcnt(0)
    v_bitop3_b32 v29, v28, s46, v12 bitop3:0x6a
    ds_read_b64_tr_b16 a[80:81], v29
    ds_read_b64_tr_b16 a[84:85], v29 offset:64
    ds_read_b128 v[16:19], v9 offset:0
    ds_read_b128 v[40:43], v9 offset:4096
    s_barrier
    s_cmp_eq_u32 s48, 0
    s_cbranch_scc1 K2_NOEMPTY
    v_lshrrev_b32 v60, 2, v0
    v_lshlrev_b32 v61, 2, v60
    ds_read_b32 v62, v61 offset:16384
    v_and_b32 v63, 3, v0
    v_mul_u32_u24 v52, 528, v60
    v_lshl_add_u32 v52, v63, 7, v52
    v_add_u32 v52, 62720, v52
    v_mov_b64 v[48:49], 0
    v_mov_b64 v[50:51], 0
    s_waitcnt lgkmcnt(0)
    v_cmp_gt_u32 vcc, 98, v60
    v_cmp_eq_u32 s[52:53], 0, v62
    s_nop 1
    s_and_b64 vcc, vcc, s[52:53]
    s_and_saveexec_b64 s[52:53], vcc
    s_cbranch_execz K2_EMPTY2
    ds_write_b128 v52, v[48:51] offset:0
    ds_write_b128 v52, v[48:51] offset:16
    ds_write_b128 v52, v[48:51] offset:32
    ds_write_b128 v52, v[48:51] offset:48
    ds_write_b128 v52, v[48:51] offset:64
    ds_write_b128 v52, v[48:51] offset:80
    ds_write_b128 v52, v[48:51] offset:96
    ds_write_b128 v52, v[48:51] offset:112
K2_EMPTY2:
    s_mov_b64 exec, s[52:53]
    s_waitcnt lgkmcnt(0)
    s_barrier
K2_NOEMPTY:
    v_add_u32 v7, 128, v7
    v_add_u32 v6, 128, v6
    v_add_u32 v8, 16, v8
    v_add_u32 v9, 16, v9
    s_waitcnt vmcnt(0)
    ds_read_b128 a[64:67], v2
    ds_read_b128 a[68:71], v3
    ds_read_b128 a[72:75], v4
    ds_read_b128 a[76:79], v5
    s_waitcnt lgkmcnt(0)
    v_mfma_f32_32x32x16_bf16 v[64:79], a[88:91], a[80:83], 0
    v_mfma_f32_32x32x16_bf16 v[64:79], a[64:67], a[0:3], v[64:79]
    v_and_or_b32 v24, v24, s45, v10
    s_mov_b32 m0, s47
    s_nop 0
    buffer_load_dwordx4 v24, s[12:15], 0 offen lds
    v_mfma_f32_32x32x16_bf16 v[64:79], a[68:71], a[8:11], v[64:79]
    v_and_or_b32 v25, v25, s45, v11
    s_add_u32 m0, m0, 1024
    s_nop 0
    buffer_load_dwordx4 v25, s[12:15], 0 offen lds
    v_mfma_f32_32x32x16_bf16 v[64:79], a[72:75], a[16:19], v[64:79]
    v_and_or_b32 v26, v26, s45, v10
    s_add_u32 m0, m0, 1024
    s_nop 0
    buffer_load_dwordx4 v26, s[12:15], 0 offen lds
    v_mfma_f32_32x32x16_bf16 v[64:79], a[76:79], a[24:27], v[64:79]
    v_and_or_b32 v27, v27, s45, v11
    s_add_u32 m0, m0, 1024
    s_nop 0
    buffer_load_dwordx4 v27, s[12:15], 0 offen lds
    v_mfma_f32_32x32x16_bf16 v[80:95], a[64:67], a[32:35], 0
    v_add_u32 v16, v16, v13
    v_add_u32 v17, v17, v13
    v_add_u32 v18, v18, v13
    v_add_u32 v19, v19, v13
    v_mfma_f32_32x32x16_bf16 v[80:95], a[68:71], a[40:43], v[80:95]
    v_mfma_f32_32x32x16_bf16 v[80:95], a[72:75], a[48:51], v[80:95]
    v_mfma_f32_32x32x16_bf16 v[80:95], a[76:79], a[56:59], v[80:95]
    s_nop 15
    s_mov_b32 s90, 256
    s_mov_b32 s91, 32
    s_mov_b32 s31, s30
.p2align 6
K2_LOOP:
    s_setprio 3
    v_mfma_f32_32x32x16_bf16 v[96:111], a[88:91], a[84:87], 0
    v_exp_f32 v64, v64
    s_waitcnt vmcnt(0)
    ds_read_b128 a[112:115], v2
    ds_read_b128 a[116:119], v3
    ds_read_b128 a[120:123], v4
    ds_read_b128 a[124:127], v5
    ds_read_b32 v28, v8 offset:0
    ds_read2_b32 v[24:25], v6 offset0:0 offset1:8
    ds_read2_b32 v[26:27], v6 offset0:16 offset1:24
    ds_read_b32 a90, v7 offset:0
    v_exp_f32 v65, v65
    v_exp_f32 v66, v66
    v_mfma_f32_32x32x16_bf16 v[96:111], a[64:67], a[4:7], v[96:111]
    v_exp_f32 v67, v67
    v_exp_f32 v68, v68
    v_exp_f32 v69, v69
    v_mfma_f32_32x32x16_bf16 v[96:111], a[68:71], a[12:15], v[96:111]
    v_exp_f32 v70, v70
    v_exp_f32 v71, v71
    v_exp_f32 v72, v72
    v_mfma_f32_32x32x16_bf16 v[96:111], a[72:75], a[20:23], v[96:111]
    v_exp_f32 v73, v73
    v_exp_f32 v74, v74
    v_exp_f32 v75, v75
    v_mfma_f32_32x32x16_bf16 v[96:111], a[76:79], a[28:31], v[96:111]
    v_exp_f32 v76, v76
    v_exp_f32 v77, v77
    v_exp_f32 v78, v78
    v_exp_f32 v79, v79
    v_pk_add_f32 v[64:65], v[64:65], 1.0 op_sel_hi:[1,0]
    v_pk_add_f32 v[66:67], v[66:67], 1.0 op_sel_hi:[1,0]
    v_pk_add_f32 v[68:69], v[68:69], 1.0 op_sel_hi:[1,0]
    v_pk_add_f32 v[70:71], v[70:71], 1.0 op_sel_hi:[1,0]
    v_pk_add_f32 v[72:73], v[72:73], 1.0 op_sel_hi:[1,0]
    v_pk_add_f32 v[74:75], v[74:75], 1.0 op_sel_hi:[1,0]
    v_pk_add_f32 v[76:77], v[76:77], 1.0 op_sel_hi:[1,0]
    v_pk_add_f32 v[78:79], v[78:79], 1.0 op_sel_hi:[1,0]
    v_mfma_f32_32x32x16_bf16 v[112:127], a[64:67], a[36:39], 0
    v_rcp_f32 v64, v64
    v_rcp_f32 v65, v65
    v_rcp_f32 v66, v66
    v_mfma_f32_32x32x16_bf16 v[112:127], a[68:71], a[44:47], v[112:127]
    v_rcp_f32 v67, v67
    v_rcp_f32 v68, v68
    v_rcp_f32 v69, v69
    v_mfma_f32_32x32x16_bf16 v[112:127], a[72:75], a[52:55], v[112:127]
    v_rcp_f32 v70, v70
    v_rcp_f32 v71, v71
    s_waitcnt lgkmcnt(0)
    v_bitop3_b32 v29, v28, s46, v12 bitop3:0x6a
    ds_read_b64_tr_b16 a[80:81], v29
    ds_read_b64_tr_b16 a[84:85], v29 offset:64
    ds_read_b128 v[20:23], v9 offset:0
    ds_read_b128 v[44:47], v9 offset:4096
    v_rcp_f32 v72, v72
    v_mfma_f32_32x32x16_bf16 v[112:127], a[76:79], a[60:63], v[112:127]
    v_rcp_f32 v73, v73
    v_rcp_f32 v74, v74
    v_rcp_f32 v75, v75
    v_and_or_b32 v24, v24, s45, v10
    s_mov_b32 m0, s47
    s_nop 0
    buffer_load_dwordx4 v24, s[12:15], 0 offen lds
    v_and_or_b32 v25, v25, s45, v11
    s_add_u32 m0, m0, 1024
    s_nop 0
    buffer_load_dwordx4 v25, s[12:15], 0 offen lds
    v_and_or_b32 v26, v26, s45, v10
    s_add_u32 m0, m0, 1024
    s_nop 0
    buffer_load_dwordx4 v26, s[12:15], 0 offen lds
    v_and_or_b32 v27, v27, s45, v11
    s_add_u32 m0, m0, 1024
    s_nop 0
    buffer_load_dwordx4 v27, s[12:15], 0 offen lds
    v_rcp_f32 v76, v76
    v_rcp_f32 v77, v77
    v_rcp_f32 v78, v78
    v_rcp_f32 v79, v79
    s_waitcnt lgkmcnt(0)
    v_pk_add_f32 v[20:21], v[20:21], v[12:13] op_sel:[0,1] op_sel_hi:[1,1]
    v_pk_add_f32 v[22:23], v[22:23], v[12:13] op_sel:[0,1] op_sel_hi:[1,1]
    v_pk_mul_f32 v[50:51], v[64:65], v[80:81]
    v_pk_add_f32 v[48:49], v[64:65], v[66:67]
    v_pk_fma_f32 v[50:51], v[66:67], v[82:83], v[50:51]
    v_add_f32 v34, v48, v49
    v_add_f32 v35, v50, v51
    v_pk_fma_f32 v[34:35], v[56:57], v[40:41], v[34:35] op_sel:[0,0,0] op_sel_hi:[1,0,1]
    v_pk_mul_f32 v[54:55], v[68:69], v[84:85]
    v_pk_add_f32 v[52:53], v[68:69], v[70:71]
    v_pk_fma_f32 v[54:55], v[70:71], v[86:87], v[54:55]
    v_add_f32 v36, v52, v53
    v_add_f32 v37, v54, v55
    v_pk_fma_f32 v[36:37], v[34:35], v[40:41], v[36:37] op_sel:[0,1,0] op_sel_hi:[1,1,1]
    v_pk_mul_f32 v[50:51], v[72:73], v[88:89]
    v_pk_add_f32 v[48:49], v[72:73], v[74:75]
    v_pk_fma_f32 v[50:51], v[74:75], v[90:91], v[50:51]
    v_add_f32 v60, v48, v49
    v_add_f32 v61, v50, v51
    v_pk_fma_f32 v[60:61], v[36:37], v[42:43], v[60:61] op_sel:[0,0,0] op_sel_hi:[1,0,1]
    v_pk_mul_f32 v[54:55], v[76:77], v[92:93]
    v_pk_add_f32 v[52:53], v[76:77], v[78:79]
    v_pk_fma_f32 v[54:55], v[78:79], v[94:95], v[54:55]
    v_add_f32 v62, v52, v53
    v_add_f32 v63, v54, v55
    v_pk_fma_f32 v[56:57], v[60:61], v[42:43], v[62:63] op_sel:[0,1,0] op_sel_hi:[1,1,1]
    ds_write2_b32 v16, v34, v35 offset0:0 offset1:64
    ds_write2_b32 v17, v36, v37 offset0:0 offset1:64
    ds_write2_b32 v18, v60, v61 offset0:0 offset1:64
    ds_write2_b32 v19, v56, v57 offset0:0 offset1:64
    s_setprio 2
    s_waitcnt lgkmcnt(4)
    v_mfma_f32_32x32x16_bf16 v[64:79], a[88:91], a[80:83], 0
    v_exp_f32 v96, v96
    v_exp_f32 v97, v97
    v_exp_f32 v98, v98
    v_mfma_f32_32x32x16_bf16 v[64:79], a[112:115], a[0:3], v[64:79]
    v_exp_f32 v99, v99
    v_exp_f32 v100, v100
    v_exp_f32 v101, v101
    v_mfma_f32_32x32x16_bf16 v[64:79], a[116:119], a[8:11], v[64:79]
    v_exp_f32 v102, v102
    v_exp_f32 v103, v103
    v_exp_f32 v104, v104
    v_mfma_f32_32x32x16_bf16 v[64:79], a[120:123], a[16:19], v[64:79]
    v_exp_f32 v105, v105
    v_exp_f32 v106, v106
    v_exp_f32 v107, v107
    v_mfma_f32_32x32x16_bf16 v[64:79], a[124:127], a[24:27], v[64:79]
    v_exp_f32 v108, v108
    v_exp_f32 v109, v109
    v_exp_f32 v110, v110
    v_exp_f32 v111, v111
    v_pk_add_f32 v[96:97], v[96:97], 1.0 op_sel_hi:[1,0]
    v_pk_add_f32 v[98:99], v[98:99], 1.0 op_sel_hi:[1,0]
    v_pk_add_f32 v[100:101], v[100:101], 1.0 op_sel_hi:[1,0]
    v_pk_add_f32 v[102:103], v[102:103], 1.0 op_sel_hi:[1,0]
    v_pk_add_f32 v[104:105], v[104:105], 1.0 op_sel_hi:[1,0]
    v_pk_add_f32 v[106:107], v[106:107], 1.0 op_sel_hi:[1,0]
    v_pk_add_f32 v[108:109], v[108:109], 1.0 op_sel_hi:[1,0]
    v_pk_add_f32 v[110:111], v[110:111], 1.0 op_sel_hi:[1,0]
    v_mfma_f32_32x32x16_bf16 v[80:95], a[112:115], a[32:35], 0
    v_rcp_f32 v96, v96
    v_rcp_f32 v97, v97
    v_rcp_f32 v98, v98
    v_mfma_f32_32x32x16_bf16 v[80:95], a[116:119], a[40:43], v[80:95]
    v_rcp_f32 v99, v99
    v_rcp_f32 v100, v100
    v_rcp_f32 v101, v101
    v_mfma_f32_32x32x16_bf16 v[80:95], a[120:123], a[48:51], v[80:95]
    v_rcp_f32 v102, v102
    v_rcp_f32 v103, v103
    v_rcp_f32 v104, v104
    v_mfma_f32_32x32x16_bf16 v[80:95], a[124:127], a[56:59], v[80:95]
    v_rcp_f32 v105, v105
    v_rcp_f32 v106, v106
    v_rcp_f32 v107, v107
    v_rcp_f32 v108, v108
    v_rcp_f32 v109, v109
    v_rcp_f32 v110, v110
    v_rcp_f32 v111, v111
    v_pk_mul_f32 v[50:51], v[96:97], v[112:113]
    v_pk_add_f32 v[48:49], v[96:97], v[98:99]
    v_pk_fma_f32 v[50:51], v[98:99], v[114:115], v[50:51]
    v_add_f32 v34, v48, v49
    v_add_f32 v35, v50, v51
    v_pk_fma_f32 v[34:35], v[58:59], v[40:41], v[34:35] op_sel:[0,0,0] op_sel_hi:[1,0,1]
    v_pk_mul_f32 v[54:55], v[100:101], v[116:117]
    v_pk_add_f32 v[52:53], v[100:101], v[102:103]
    v_pk_fma_f32 v[54:55], v[102:103], v[118:119], v[54:55]
    v_add_f32 v36, v52, v53
    v_add_f32 v37, v54, v55
    v_pk_fma_f32 v[36:37], v[34:35], v[40:41], v[36:37] op_sel:[0,1,0] op_sel_hi:[1,1,1]
    v_pk_mul_f32 v[50:51], v[104:105], v[120:121]
    v_pk_add_f32 v[48:49], v[104:105], v[106:107]
    v_pk_fma_f32 v[50:51], v[106:107], v[122:123], v[50:51]
    v_add_f32 v60, v48, v49
    v_add_f32 v61, v50, v51
    v_pk_fma_f32 v[60:61], v[36:37], v[42:43], v[60:61] op_sel:[0,0,0] op_sel_hi:[1,0,1]
    v_pk_mul_f32 v[54:55], v[108:109], v[124:125]
    v_pk_add_f32 v[52:53], v[108:109], v[110:111]
    v_pk_fma_f32 v[54:55], v[110:111], v[126:127], v[54:55]
    v_add_f32 v62, v52, v53
    v_add_f32 v63, v54, v55
    v_pk_fma_f32 v[58:59], v[60:61], v[42:43], v[62:63] op_sel:[0,1,0] op_sel_hi:[1,1,1]
    ds_write2_b32 v16, v34, v35 offset0:32 offset1:96
    ds_write2_b32 v17, v36, v37 offset0:32 offset1:96
    ds_write2_b32 v18, v60, v61 offset0:32 offset1:96
    ds_write2_b32 v19, v58, v59 offset0:32 offset1:96
    s_sub_u32 s31, s31, 1
    s_cmp_eq_u32 s31, 0
    s_cbranch_scc1 K2_LOOP_END
    s_setprio 1
    v_mfma_f32_32x32x16_bf16 v[96:111], a[88:91], a[84:87], 0
    v_exp_f32 v64, v64
    s_waitcnt vmcnt(0)
    ds_read_b128 a[64:67], v2
    ds_read_b128 a[68:71], v3
    ds_read_b128 a[72:75], v4
    ds_read_b128 a[76:79], v5
    ds_read_b32 v28, v8 offset:16
    ds_read2_b32 v[24:25], v6 offset0:32 offset1:40
    ds_read2_b32 v[26:27], v6 offset0:48 offset1:56
    ds_read_b32 a90, v7 offset:128
    v_exp_f32 v65, v65
    v_exp_f32 v66, v66
    v_mfma_f32_32x32x16_bf16 v[96:111], a[112:115], a[4:7], v[96:111]
    v_exp_f32 v67, v67
    v_exp_f32 v68, v68
    v_exp_f32 v69, v69
    v_mfma_f32_32x32x16_bf16 v[96:111], a[116:119], a[12:15], v[96:111]
    v_exp_f32 v70, v70
    v_exp_f32 v71, v71
    v_exp_f32 v72, v72
    v_mfma_f32_32x32x16_bf16 v[96:111], a[120:123], a[20:23], v[96:111]
    v_exp_f32 v73, v73
    v_exp_f32 v74, v74
    v_exp_f32 v75, v75
    v_mfma_f32_32x32x16_bf16 v[96:111], a[124:127], a[28:31], v[96:111]
    v_exp_f32 v76, v76
    v_exp_f32 v77, v77
    v_exp_f32 v78, v78
    v_exp_f32 v79, v79
    v_pk_add_f32 v[64:65], v[64:65], 1.0 op_sel_hi:[1,0]
    v_pk_add_f32 v[66:67], v[66:67], 1.0 op_sel_hi:[1,0]
    v_pk_add_f32 v[68:69], v[68:69], 1.0 op_sel_hi:[1,0]
    v_pk_add_f32 v[70:71], v[70:71], 1.0 op_sel_hi:[1,0]
    v_pk_add_f32 v[72:73], v[72:73], 1.0 op_sel_hi:[1,0]
    v_pk_add_f32 v[74:75], v[74:75], 1.0 op_sel_hi:[1,0]
    v_pk_add_f32 v[76:77], v[76:77], 1.0 op_sel_hi:[1,0]
    v_pk_add_f32 v[78:79], v[78:79], 1.0 op_sel_hi:[1,0]
    v_mfma_f32_32x32x16_bf16 v[112:127], a[112:115], a[36:39], 0
    v_rcp_f32 v64, v64
    v_rcp_f32 v65, v65
    v_rcp_f32 v66, v66
    v_mfma_f32_32x32x16_bf16 v[112:127], a[116:119], a[44:47], v[112:127]
    v_rcp_f32 v67, v67
    v_rcp_f32 v68, v68
    v_rcp_f32 v69, v69
    v_mfma_f32_32x32x16_bf16 v[112:127], a[120:123], a[52:55], v[112:127]
    v_rcp_f32 v70, v70
    v_rcp_f32 v71, v71
    s_waitcnt lgkmcnt(0)
    v_bitop3_b32 v29, v28, s46, v12 bitop3:0x6a
    ds_read_b64_tr_b16 a[80:81], v29
    ds_read_b64_tr_b16 a[84:85], v29 offset:64
    ds_read_b128 v[16:19], v9 offset:16
    ds_read_b128 v[40:43], v9 offset:4112
    v_rcp_f32 v72, v72
    v_mfma_f32_32x32x16_bf16 v[112:127], a[124:127], a[60:63], v[112:127]
    v_rcp_f32 v73, v73
    v_rcp_f32 v74, v74
    v_rcp_f32 v75, v75
    v_and_or_b32 v24, v24, s45, v10
    s_mov_b32 m0, s47
    s_nop 0
    buffer_load_dwordx4 v24, s[12:15], 0 offen lds
    v_and_or_b32 v25, v25, s45, v11
    s_add_u32 m0, m0, 1024
    s_nop 0
    buffer_load_dwordx4 v25, s[12:15], 0 offen lds
    v_and_or_b32 v26, v26, s45, v10
    s_add_u32 m0, m0, 1024
    s_nop 0
    buffer_load_dwordx4 v26, s[12:15], 0 offen lds
    v_and_or_b32 v27, v27, s45, v11
    s_add_u32 m0, m0, 1024
    s_nop 0
    buffer_load_dwordx4 v27, s[12:15], 0 offen lds
    v_rcp_f32 v76, v76
    v_rcp_f32 v77, v77
    v_rcp_f32 v78, v78
    v_rcp_f32 v79, v79
    s_waitcnt lgkmcnt(0)
    v_pk_add_f32 v[16:17], v[16:17], v[12:13] op_sel:[0,1] op_sel_hi:[1,1]
    v_pk_add_f32 v[18:19], v[18:19], v[12:13] op_sel:[0,1] op_sel_hi:[1,1]
    v_pk_add_f32 v[6:7], v[6:7], s[90:91] op_sel:[0,0] op_sel_hi:[1,0]
    v_pk_add_f32 v[8:9], v[8:9], s[90:91] op_sel:[0,1] op_sel_hi:[1,1]
    v_pk_mul_f32 v[50:51], v[64:65], v[80:81]
    v_pk_add_f32 v[48:49], v[64:65], v[66:67]
    v_pk_fma_f32 v[50:51], v[66:67], v[82:83], v[50:51]
    v_add_f32 v34, v48, v49
    v_add_f32 v35, v50, v51
    v_pk_fma_f32 v[34:35], v[56:57], v[44:45], v[34:35] op_sel:[0,0,0] op_sel_hi:[1,0,1]
    v_pk_mul_f32 v[54:55], v[68:69], v[84:85]
    v_pk_add_f32 v[52:53], v[68:69], v[70:71]
    v_pk_fma_f32 v[54:55], v[70:71], v[86:87], v[54:55]
    v_add_f32 v36, v52, v53
    v_add_f32 v37, v54, v55
    v_pk_fma_f32 v[36:37], v[34:35], v[44:45], v[36:37] op_sel:[0,1,0] op_sel_hi:[1,1,1]
    v_pk_mul_f32 v[50:51], v[72:73], v[88:89]
    v_pk_add_f32 v[48:49], v[72:73], v[74:75]
    v_pk_fma_f32 v[50:51], v[74:75], v[90:91], v[50:51]
    v_add_f32 v60, v48, v49
    v_add_f32 v61, v50, v51
    v_pk_fma_f32 v[60:61], v[36:37], v[46:47], v[60:61] op_sel:[0,0,0] op_sel_hi:[1,0,1]
    v_pk_mul_f32 v[54:55], v[76:77], v[92:93]
    v_pk_add_f32 v[52:53], v[76:77], v[78:79]
    v_pk_fma_f32 v[54:55], v[78:79], v[94:95], v[54:55]
    v_add_f32 v62, v52, v53
    v_add_f32 v63, v54, v55
    v_pk_fma_f32 v[56:57], v[60:61], v[46:47], v[62:63] op_sel:[0,1,0] op_sel_hi:[1,1,1]
    ds_write2_b32 v20, v34, v35 offset0:0 offset1:64
    ds_write2_b32 v21, v36, v37 offset0:0 offset1:64
    ds_write2_b32 v22, v60, v61 offset0:0 offset1:64
    ds_write2_b32 v23, v56, v57 offset0:0 offset1:64
    s_setprio 0
    s_waitcnt lgkmcnt(4)
    v_mfma_f32_32x32x16_bf16 v[64:79], a[88:91], a[80:83], 0
    v_exp_f32 v96, v96
    v_exp_f32 v97, v97
    v_exp_f32 v98, v98
    v_mfma_f32_32x32x16_bf16 v[64:79], a[64:67], a[0:3], v[64:79]
    v_exp_f32 v99, v99
    v_exp_f32 v100, v100
    v_exp_f32 v101, v101
    v_mfma_f32_32x32x16_bf16 v[64:79], a[68:71], a[8:11], v[64:79]
    v_exp_f32 v102, v102
    v_exp_f32 v103, v103
    v_exp_f32 v104, v104
    v_mfma_f32_32x32x16_bf16 v[64:79], a[72:75], a[16:19], v[64:79]
    v_exp_f32 v105, v105
    v_exp_f32 v106, v106
    v_exp_f32 v107, v107
    v_mfma_f32_32x32x16_bf16 v[64:79], a[76:79], a[24:27], v[64:79]
    v_exp_f32 v108, v108
    v_exp_f32 v109, v109
    v_exp_f32 v110, v110
    v_exp_f32 v111, v111
    v_pk_add_f32 v[96:97], v[96:97], 1.0 op_sel_hi:[1,0]
    v_pk_add_f32 v[98:99], v[98:99], 1.0 op_sel_hi:[1,0]
    v_pk_add_f32 v[100:101], v[100:101], 1.0 op_sel_hi:[1,0]
    v_pk_add_f32 v[102:103], v[102:103], 1.0 op_sel_hi:[1,0]
    v_pk_add_f32 v[104:105], v[104:105], 1.0 op_sel_hi:[1,0]
    v_pk_add_f32 v[106:107], v[106:107], 1.0 op_sel_hi:[1,0]
    v_pk_add_f32 v[108:109], v[108:109], 1.0 op_sel_hi:[1,0]
    v_pk_add_f32 v[110:111], v[110:111], 1.0 op_sel_hi:[1,0]
    v_mfma_f32_32x32x16_bf16 v[80:95], a[64:67], a[32:35], 0
    v_rcp_f32 v96, v96
    v_rcp_f32 v97, v97
    v_rcp_f32 v98, v98
    v_mfma_f32_32x32x16_bf16 v[80:95], a[68:71], a[40:43], v[80:95]
    v_rcp_f32 v99, v99
    v_rcp_f32 v100, v100
    v_rcp_f32 v101, v101
    v_mfma_f32_32x32x16_bf16 v[80:95], a[72:75], a[48:51], v[80:95]
    v_rcp_f32 v102, v102
    v_rcp_f32 v103, v103
    v_rcp_f32 v104, v104
    v_mfma_f32_32x32x16_bf16 v[80:95], a[76:79], a[56:59], v[80:95]
    v_rcp_f32 v105, v105
    v_rcp_f32 v106, v106
    v_rcp_f32 v107, v107
    v_rcp_f32 v108, v108
    v_rcp_f32 v109, v109
    v_rcp_f32 v110, v110
    v_rcp_f32 v111, v111
    v_pk_mul_f32 v[50:51], v[96:97], v[112:113]
    v_pk_add_f32 v[48:49], v[96:97], v[98:99]
    v_pk_fma_f32 v[50:51], v[98:99], v[114:115], v[50:51]
    v_add_f32 v34, v48, v49
    v_add_f32 v35, v50, v51
    v_pk_fma_f32 v[34:35], v[58:59], v[44:45], v[34:35] op_sel:[0,0,0] op_sel_hi:[1,0,1]
    v_pk_mul_f32 v[54:55], v[100:101], v[116:117]
    v_pk_add_f32 v[52:53], v[100:101], v[102:103]
    v_pk_fma_f32 v[54:55], v[102:103], v[118:119], v[54:55]
    v_add_f32 v36, v52, v53
    v_add_f32 v37, v54, v55
    v_pk_fma_f32 v[36:37], v[34:35], v[44:45], v[36:37] op_sel:[0,1,0] op_sel_hi:[1,1,1]
    v_pk_mul_f32 v[50:51], v[104:105], v[120:121]
    v_pk_add_f32 v[48:49], v[104:105], v[106:107]
    v_pk_fma_f32 v[50:51], v[106:107], v[122:123], v[50:51]
    v_add_f32 v60, v48, v49
    v_add_f32 v61, v50, v51
    v_pk_fma_f32 v[60:61], v[36:37], v[46:47], v[60:61] op_sel:[0,0,0] op_sel_hi:[1,0,1]
    v_pk_mul_f32 v[54:55], v[108:109], v[124:125]
    v_pk_add_f32 v[52:53], v[108:109], v[110:111]
    v_pk_fma_f32 v[54:55], v[110:111], v[126:127], v[54:55]
    v_add_f32 v62, v52, v53
    v_add_f32 v63, v54, v55
    v_pk_fma_f32 v[58:59], v[60:61], v[46:47], v[62:63] op_sel:[0,1,0] op_sel_hi:[1,1,1]
    ds_write2_b32 v20, v34, v35 offset0:32 offset1:96
    ds_write2_b32 v21, v36, v37 offset0:32 offset1:96
    ds_write2_b32 v22, v60, v61 offset0:32 offset1:96
    ds_write2_b32 v23, v58, v59 offset0:32 offset1:96
    s_sub_u32 s31, s31, 1
    s_cmp_lg_u32 s31, 0
    s_cbranch_scc1 K2_LOOP
K2_LOOP_END:
    s_setprio 0
    s_waitcnt vmcnt(0)
    s_lshl_b32 s3, s29, 11
    v_lshrrev_b32 v40, 3, v1
    v_lshlrev_b32 v40, 7, v40
    v_add_u32 v40, s3, v40
    v_add_u32 v41, v40, v11
    v_add_u32 v40, v40, v10
    v_add_u32 v41, 1024, v41
    s_mov_b32 m0, s47
    s_nop 0
    buffer_load_dwordx4 v40, s[16:19], 0 offen lds
    s_add_u32 m0, m0, 1024
    s_nop 0
    buffer_load_dwordx4 v41, s[16:19], 0 offen lds
    v_lshlrev_b32 v40, 2, v1
    ds_read_b32 v41, v40 offset:18432
    ds_read_b32 v42, v40 offset:18436
    v_mov_b32 v43, 18496
    ds_read_b32 v44, v43
    s_lshl_b32 s3, s29, 1
    v_add_u32 v45, s3, v15
    v_lshlrev_b32 v46, 2, v45
    ds_read_b32 v47, v46 offset:18432
    v_mul_u32_u24 v45, 528, v45
    v_add_u32 v45, 114464, v45
    v_add_u32 v45, v45, v13
    s_waitcnt lgkmcnt(0)
    v_readfirstlane_b32 s38, v44
    v_cmp_eq_u32 vcc, v41, v42
    v_cmp_le_i32 s[52:53], 0, v41
    v_mul_i32_i24 v46, 528, v47
    s_nop 0
    s_and_b64 vcc, vcc, s[52:53]
    s_and_b32 s54, vcc_lo, 0x7fff
    v_cmp_le_i32 s[88:89], 0, v47
    v_add_u32 v46, 62720, v46
    v_add_u32 v47, v46, v13
    s_barrier
    s_cmp_lg_u32 s54, 0
    s_cbranch_scc1 K2_FIX_SLOW
    s_mov_b64 s[52:53], exec
    s_and_b64 exec, exec, s[88:89]
    s_cbranch_execz K2_FIX_DONE
    ds_read_b32 v16, v45 offset:0
    ds_read_b32 v20, v47 offset:0
    ds_read_b32 v17, v45 offset:128
    ds_read_b32 v21, v47 offset:128
    ds_read_b32 v18, v45 offset:256
    ds_read_b32 v22, v47 offset:256
    ds_read_b32 v19, v45 offset:384
    ds_read_b32 v23, v47 offset:384
    s_waitcnt lgkmcnt(0)
    v_add_f32 v16, v16, v20
    ds_write_b32 v47, v16 offset:0
    v_add_f32 v17, v17, v21
    ds_write_b32 v47, v17 offset:128
    v_add_f32 v18, v18, v22
    ds_write_b32 v47, v18 offset:256
    v_add_f32 v19, v19, v23
    ds_write_b32 v47, v19 offset:384
    s_branch K2_FIX_DONE
K2_FIX_SLOW:
    s_mov_b64 s[52:53], exec
    s_cmp_lg_u32 s29, 0
    s_cbranch_scc1 K2_FIX_DONE
    s_mov_b32 s3, 0
K2_FIX_SL:
    v_readlane_b32 s49, v41, s3
    s_nop 3
    s_cmp_lt_i32 s49, 0
    s_cbranch_scc1 K2_FIX_SN
    s_mul_i32 s49, s49, 528
    s_add_u32 s49, s49, 62720
    s_mul_i32 s54, s3, 528
    s_add_u32 s54, s54, 114464
    v_lshlrev_b32 v45, 3, v1
    v_add_u32 v46, s54, v45
    v_add_u32 v47, s49, v45
    ds_read_b64 v[16:17], v46
    ds_read_b64 v[18:19], v47
    s_waitcnt lgkmcnt(0)
    v_add_f32 v16, v16, v18
    v_add_f32 v17, v17, v19
    ds_write_b64 v47, v[16:17]
    s_waitcnt lgkmcnt(0)
K2_FIX_SN:
    s_add_u32 s3, s3, 1
    s_cmp_lt_u32 s3, 16
    s_cbranch_scc1 K2_FIX_SL
K2_FIX_DONE:
    s_mov_b64 exec, s[52:53]
    s_waitcnt vmcnt(0) lgkmcnt(0)
    s_barrier
    s_or_b32 s3, s37, s38
    s_cmp_eq_u32 s3, 0
    s_cbranch_scc1 K2_EPI
    s_mul_i32 s3, s28, 51744
    s_add_u32 s3, s3, 8388608
    v_lshlrev_b32 v40, 4, v0
    v_add_u32 v41, 62720, v40
    v_add_u32 v42, s3, v40
    s_mov_b32 s49, 0
K2_MR:
    v_cmp_gt_u32 vcc, 51744, v40
    s_and_saveexec_b64 s[52:53], vcc
    s_cbranch_execz K2_MR_N
    ds_read_b128 v[16:19], v41
    s_cmp_eq_u32 s37, 0
    s_cbranch_scc1 K2_MR_A
    buffer_load_dwordx4 v[20:23], v42, s[24:27], 0 offen
    s_waitcnt vmcnt(0) lgkmcnt(0)
    v_add_f32 v16, v16, v20
    v_add_f32 v17, v17, v21
    v_add_f32 v18, v18, v22
    v_add_f32 v19, v19, v23
    ds_write_b128 v41, v[16:19]
K2_MR_A:
    s_waitcnt lgkmcnt(0)
    s_cmp_eq_u32 s38, 0
    s_cbranch_scc1 K2_MR_N
    buffer_store_dwordx4 v[16:19], v42, s[24:27], 0 offen
    s_waitcnt vmcnt(0)
K2_MR_N:
    s_mov_b64 exec, s[52:53]
    v_add_u32 v40, 8192, v40
    v_add_u32 v41, 8192, v41
    v_add_u32 v42, 8192, v42
    s_add_u32 s49, s49, 1
    s_cmp_lt_u32 s49, 7
    s_cbranch_scc1 K2_MR
    s_waitcnt vmcnt(0) lgkmcnt(0)
    s_barrier
    s_cmp_eq_u32 s38, 0
    s_cbranch_scc1 K2_EPI
    s_mov_b32 s37, 1
    s_branch K2_ROUND_INIT
K2_EPI:
    s_lshl_b32 s3, s50, 5
    v_add_u32 v2, s3, v14
    v_mul_u32_u24 v3, 528, v2
    s_lshl_b32 s49, s51, 7
    s_add_u32 s49, s49, 62720
    v_lshl_add_u32 v3, v15, 4, v3
    v_add_u32 v3, s49, v3
    ds_read_b128 v[64:67], v3 offset:0
    ds_read_b128 v[68:71], v3 offset:32
    ds_read_b128 v[72:75], v3 offset:64
    ds_read_b128 v[76:79], v3 offset:96
    v_bfe_u32 v4, v14, 1, 3
    s_lshl_b32 s49, s51, 2
    v_xor_b32 v4, s49, v4
    v_lshlrev_b32 v4, 4, v4
    v_lshl_add_u32 v4, v15, 3, v4
    v_and_b32 v5, 15, v14
    v_lshl_add_u32 v4, v5, 7, v4
    v_lshrrev_b32 v5, 4, v14
    v_lshl_add_u32 v4, v5, 12, v4
    s_lshl_b32 s3, s50, 13
    s_add_u32 s3, s3, 123008
    v_add_u32 v4, s3, v4
    v_xor_b32 v5, 16, v4
    v_xor_b32 v6, 32, v4
    v_xor_b32 v7, 48, v4
    ds_read_b128 v[80:83], v3 offset:256
    ds_read_b128 v[84:87], v3 offset:288
    ds_read_b128 v[88:91], v3 offset:320
    ds_read_b128 v[92:95], v3 offset:352
    ds_read_b64 v[96:97], v4
    ds_read_b64 v[98:99], v5
    ds_read_b64 v[100:101], v6
    ds_read_b64 v[102:103], v7
    v_and_b32 v8, 7, v14
    s_lshl_b32 s49, s51, 2
    v_xor_b32 v8, s49, v8
    v_lshlrev_b32 v8, 4, v8
    v_lshl_add_u32 v8, v15, 3, v8
    v_lshl_add_u32 v8, v2, 7, v8
    v_xor_b32 v9, 16, v8
    v_xor_b32 v10, 32, v8
    v_xor_b32 v11, 48, v8
    s_mov_b32 s48, 0x358637bd
    s_mov_b32 s49, 0x358637bd
    v_accvgpr_read_b32 v112, a96
    v_accvgpr_read_b32 v113, a97
    v_accvgpr_read_b32 v114, a98
    v_accvgpr_read_b32 v115, a99
    v_accvgpr_read_b32 v116, a100
    v_accvgpr_read_b32 v117, a101
    v_accvgpr_read_b32 v118, a102
    v_accvgpr_read_b32 v119, a103
    v_accvgpr_read_b32 v120, a104
    v_accvgpr_read_b32 v121, a105
    v_accvgpr_read_b32 v122, a106
    v_accvgpr_read_b32 v123, a107
    v_accvgpr_read_b32 v124, a108
    v_accvgpr_read_b32 v125, a109
    v_accvgpr_read_b32 v126, a110
    v_accvgpr_read_b32 v127, a111
    s_waitcnt lgkmcnt(8)
    v_pk_add_f32 v[64:65], v[64:65], s[48:49]
    v_pk_add_f32 v[66:67], v[66:67], s[48:49]
    v_pk_add_f32 v[68:69], v[68:69], s[48:49]
    v_pk_add_f32 v[70:71], v[70:71], s[48:49]
    v_pk_add_f32 v[72:73], v[72:73], s[48:49]
    v_pk_add_f32 v[74:75], v[74:75], s[48:49]
    v_pk_add_f32 v[76:77], v[76:77], s[48:49]
    v_pk_add_f32 v[78:79], v[78:79], s[48:49]
    v_rcp_f32 v64, v64
    v_rcp_f32 v65, v65
    v_rcp_f32 v66, v66
    v_rcp_f32 v67, v67
    v_rcp_f32 v68, v68
    v_rcp_f32 v69, v69
    v_rcp_f32 v70, v70
    v_rcp_f32 v71, v71
    v_rcp_f32 v72, v72
    v_rcp_f32 v73, v73
    v_rcp_f32 v74, v74
    v_rcp_f32 v75, v75
    v_rcp_f32 v76, v76
    v_rcp_f32 v77, v77
    v_rcp_f32 v78, v78
    v_rcp_f32 v79, v79
    s_waitcnt lgkmcnt(0)
    v_pk_fma_f32 v[112:113], v[80:81], v[64:65], v[112:113]
    v_pk_fma_f32 v[114:115], v[82:83], v[66:67], v[114:115]
    v_pk_fma_f32 v[116:117], v[84:85], v[68:69], v[116:117]
    v_pk_fma_f32 v[118:119], v[86:87], v[70:71], v[118:119]
    v_pk_fma_f32 v[120:121], v[88:89], v[72:73], v[120:121]
    v_pk_fma_f32 v[122:123], v[90:91], v[74:75], v[122:123]
    v_pk_fma_f32 v[124:125], v[92:93], v[76:77], v[124:125]
    v_pk_fma_f32 v[126:127], v[94:95], v[78:79], v[126:127]
    v_max_f32 v112, 0, v112
    v_max_f32 v113, 0, v113
    v_max_f32 v114, 0, v114
    v_max_f32 v115, 0, v115
    v_max_f32 v116, 0, v116
    v_max_f32 v117, 0, v117
    v_max_f32 v118, 0, v118
    v_max_f32 v119, 0, v119
    v_max_f32 v120, 0, v120
    v_max_f32 v121, 0, v121
    v_max_f32 v122, 0, v122
    v_max_f32 v123, 0, v123
    v_max_f32 v124, 0, v124
    v_max_f32 v125, 0, v125
    v_max_f32 v126, 0, v126
    v_max_f32 v127, 0, v127
    v_lshlrev_b32 v64, 16, v96
    v_and_b32 v65, 0xffff0000, v96
    v_lshlrev_b32 v66, 16, v97
    v_and_b32 v67, 0xffff0000, v97
    v_lshlrev_b32 v68, 16, v98
    v_and_b32 v69, 0xffff0000, v98
    v_lshlrev_b32 v70, 16, v99
    v_and_b32 v71, 0xffff0000, v99
    v_lshlrev_b32 v72, 16, v100
    v_and_b32 v73, 0xffff0000, v100
    v_lshlrev_b32 v74, 16, v101
    v_and_b32 v75, 0xffff0000, v101
    v_lshlrev_b32 v76, 16, v102
    v_and_b32 v77, 0xffff0000, v102
    v_lshlrev_b32 v78, 16, v103
    v_and_b32 v79, 0xffff0000, v103
    v_pk_add_f32 v[112:113], v[112:113], v[64:65]
    v_pk_add_f32 v[114:115], v[114:115], v[66:67]
    v_pk_add_f32 v[116:117], v[116:117], v[68:69]
    v_pk_add_f32 v[118:119], v[118:119], v[70:71]
    v_pk_add_f32 v[120:121], v[120:121], v[72:73]
    v_pk_add_f32 v[122:123], v[122:123], v[74:75]
    v_pk_add_f32 v[124:125], v[124:125], v[76:77]
    v_pk_add_f32 v[126:127], v[126:127], v[78:79]
    v_cvt_pk_bf16_f32 v80, v112, v113
    v_cvt_pk_bf16_f32 v81, v114, v115
    v_cvt_pk_bf16_f32 v82, v116, v117
    v_cvt_pk_bf16_f32 v83, v118, v119
    v_cvt_pk_bf16_f32 v84, v120, v121
    v_cvt_pk_bf16_f32 v85, v122, v123
    v_cvt_pk_bf16_f32 v86, v124, v125
    v_cvt_pk_bf16_f32 v87, v126, v127
    ds_write_b64 v8, v[80:81] offset:0
    ds_write_b64 v9, v[82:83] offset:0
    ds_write_b64 v10, v[84:85] offset:0
    ds_write_b64 v11, v[86:87] offset:0
    v_lshlrev_b32 v5, 4, v0
    v_lshrrev_b32 v6, 3, v0
    v_and_b32 v7, 7, v6
    v_lshlrev_b32 v7, 4, v7
    v_xor_b32 v6, v5, v7
    v_add_u32 v7, 8192, v6
    s_waitcnt lgkmcnt(0)
    s_barrier
    ds_read_b128 v[64:67], v5 offset:0
    ds_read_b128 v[68:71], v5 offset:8192
    s_waitcnt lgkmcnt(1)
    buffer_store_dwordx4 v[64:67], v6, s[20:23], 0 offen sc1
    s_waitcnt lgkmcnt(0)
    buffer_store_dwordx4 v[68:71], v7, s[20:23], 0 offen sc1
K2_END:
    s_endpgm
K2_CODE_END:
.section .rodata,"a"
.p2align 6
.amdhsa_kernel k1_kernel
  .amdhsa_next_free_vgpr 96
  .amdhsa_next_free_sgpr 40
  .amdhsa_accum_offset 96
  .amdhsa_group_segment_fixed_size 0
  .amdhsa_kernarg_size 96
  .amdhsa_user_sgpr_count 2
  .amdhsa_user_sgpr_kernarg_segment_ptr 1
  .amdhsa_system_sgpr_workgroup_id_x 1
  .amdhsa_float_denorm_mode_32 3
.end_amdhsa_kernel
.amdhsa_kernel k2_kernel
  .amdhsa_next_free_vgpr 256
  .amdhsa_next_free_sgpr 100
  .amdhsa_accum_offset 128
  .amdhsa_group_segment_fixed_size 0
  .amdhsa_kernarg_size 96
  .amdhsa_user_sgpr_count 2
  .amdhsa_user_sgpr_kernarg_segment_ptr 1
  .amdhsa_system_sgpr_workgroup_id_x 1
  .amdhsa_float_denorm_mode_32 3
.end_amdhsa_kernel
```
